```python
import torch

def _softmax(x, axis=-1):
    return torch.softmax(x, dim=axis)
def _gelu(x):
    return torch.nn.functional.gelu(x, approximate="tanh")
def _silu(x):
    return torch.nn.functional.silu(x)
def _sigmoid(x):
    return torch.sigmoid(x)
def _layernorm(x, axis=-1, eps=1e-5):
    m = x.mean(dim=axis, keepdim=True)
    v = x.var(dim=axis, keepdim=True, unbiased=False)
    return (x - m) / torch.sqrt(v + eps)
def _scatter_add(tgt, idx, src, axis=0):
    return tgt.clone().index_add_(axis, idx, src)
def _segment_sum(src, seg, n):
    out = torch.zeros((n,) + src.shape[1:], dtype=src.dtype)
    return out.index_add_(0, seg, src)
def _pad(x, pw):
    flat = tuple(v for pair in reversed(pw) for v in pair)
    return torch.nn.functional.pad(x, flat)

kernel_name = 'concat_heads__mha_block_cached__mha_block_cached__near_ridge'

def setup_inputs():

    _w = (lambda a: (lambda t: t.to(torch.bfloat16) if t.is_floating_point() else t)(torch.as_tensor(a)))
    def _A_setup():
        B, Sq, D = 16, 160, 512
        H, Sk, Dh = 32, 512, 128
        return {
            "x": _w((lambda *s: torch.randn(*s, dtype=torch.bfloat16) * 0.8)(B, Sq, D)),
            "k_cache": _w((lambda *s: torch.randn(*s, dtype=torch.bfloat16) * 0.8)(B, H, Sk, Dh)),
            "v_cache": _w((lambda *s: torch.randn(*s, dtype=torch.bfloat16) * 0.05)(B, H, Sk, Dh)),
            "wq": _w((lambda *s: torch.randn(*s, dtype=torch.bfloat16) * 0.8)(D, H * Dh) * (D ** -0.5)),
            "wo": _w((lambda *s: torch.randn(*s, dtype=torch.bfloat16) * 0.05)(H * Dh, D) * ((H * Dh) ** -0.5)),
        }
    _A_in = _A_setup()

    def _B_setup():
        B, Sq, D = 16, 160, 512
        H, Sk, Dh = 32, 512, 128
        return {
            "x": _w((lambda *s: torch.randn(*s, dtype=torch.bfloat16) * 0.8)(B, Sq, D)),
            "k_cache": _w((lambda *s: torch.randn(*s, dtype=torch.bfloat16) * 0.8)(B, H, Sk, Dh)),
            "v_cache": _w((lambda *s: torch.randn(*s, dtype=torch.bfloat16) * 0.05)(B, H, Sk, Dh)),
            "wq": _w((lambda *s: torch.randn(*s, dtype=torch.bfloat16) * 0.8)(D, H * Dh) * (D ** -0.5)),
            "wo": _w((lambda *s: torch.randn(*s, dtype=torch.bfloat16) * 0.05)(H * Dh, D) * ((H * Dh) ** -0.5)),
        }
    _B_in = _B_setup()

    return {
        "A_x": _A_in["x"],
        "A_k_cache": _A_in["k_cache"],
        "A_v_cache": _A_in["v_cache"],
        "A_wq": _A_in["wq"],
        "A_wo": _A_in["wo"],
        "B_x": _B_in["x"],
        "B_k_cache": _B_in["k_cache"],
        "B_v_cache": _B_in["v_cache"],
        "B_wq": _B_in["wq"],
        "B_wo": _B_in["wo"],
    }

def reference(A_x, A_k_cache, A_v_cache, A_wq, A_wo, B_x, B_k_cache, B_v_cache, B_wq, B_wo):
    def _A_ref(x, k_cache, v_cache, wq, wo):
        B, Sq, D = x.shape
        H, Dh = 32, 128
        q = (lambda x, *d: x.permute(*d))((x @ wq).reshape(B, Sq, H, Dh), 0, 2, 1, 3)
        scores = torch.einsum("bhqd,bhkd->bhqk", q, k_cache) * (Dh ** -0.5)
        p = _softmax(scores, axis=-1)
        o = torch.einsum("bhqk,bhkd->bhqd", p, v_cache)
        return (lambda x, *d: x.permute(*d))(o, 0, 2, 1, 3).reshape(B, Sq, H * Dh) @ wo

    def _B_ref(x, k_cache, v_cache, wq, wo):
        B, Sq, D = x.shape
        H, Dh = 32, 128
        q = (lambda x, *d: x.permute(*d))((x @ wq).reshape(B, Sq, H, Dh), 0, 2, 1, 3)
        scores = torch.einsum("bhqd,bhkd->bhqk", q, k_cache) * (Dh ** -0.5)
        p = _softmax(scores, axis=-1)
        o = torch.einsum("bhqk,bhkd->bhqd", p, v_cache)
        return (lambda x, *d: x.permute(*d))(o, 0, 2, 1, 3).reshape(B, Sq, H * Dh) @ wo

    a = _A_ref(A_x, A_k_cache, A_v_cache, A_wq, A_wo)
    b = _B_ref(B_x, B_k_cache, B_v_cache, B_wq, B_wo)
    return torch.concatenate([a, b], axis=-1)
```

```asm
; @launch grid=(256,1,1) block=(256,1,1) lds=163840
.amdgcn_target "amdgcn-amd-amdhsa--gfx950"
.text
.globl concat_heads__mha_block_cached__mha_block_cached__near_ridge_kernel
.p2align 8
.type concat_heads__mha_block_cached__mha_block_cached__near_ridge_kernel,@function
concat_heads__mha_block_cached__mha_block_cached__near_ridge_kernel:
    s_cmp_ge_u32 s2, 256
    s_cbranch_scc1 L_end
    s_load_dwordx16 s[64:79], s[0:1], 0
    s_load_dwordx8 s[80:87], s[0:1], 64
    s_load_dwordx2 s[88:89], s[0:1], 96
    v_lshrrev_b32 v1, 6, v0
    v_and_b32 v172, 63, v0
    v_readfirstlane_b32 s32, v1
    v_and_b32 v173, 15, v0
    v_bfe_u32 v174, v0, 4, 2
    v_bfe_u32 v175, v0, 2, 2
    v_and_b32 v176, 3, v0
    s_lshr_b32 s33, s32, 1
    s_and_b32 s34, s32, 1
    s_and_b32 s42, s2, 7
    s_lshr_b32 s43, s2, 3
    s_lshr_b32 s44, s43, 3
    s_lshl_b32 s42, s42, 2
    s_add_u32 s44, s44, s42
    s_and_b32 s45, s43, 7
    s_and_b32 s42, s2, 7
    s_lshr_b32 s44, s42, 1
    s_lshl_b32 s44, s44, 3
    s_lshr_b32 s45, s43, 2
    s_add_u32 s44, s44, s45
    s_and_b32 s45, s42, 1
    s_lshl_b32 s45, s45, 2
    s_and_b32 s42, s43, 3
    s_add_u32 s45, s45, s42
    s_lshr_b32 s46, s44, 4
    s_and_b32 s47, s44, 15
    s_lshl_b32 s62, s45, 1
    s_add_u32 s62, s62, s47
    s_and_b32 s62, s62, 7
    s_lshl_b32 s48, s33, 16
    s_lshl_b32 s63, s34, 12
    s_add_u32 s39, s48, s63
    s_cmp_eq_u32 s33, 0
    s_mov_b32 s49, 90112
    s_cselect_b32 s49, 122880, s49
    s_add_u32 s50, s49, s63
    s_mul_i32 s51, s32, 5120
    s_add_u32 s51, s51, 24576
    s_mul_i32 s52, s32, 40960
    s_lshl_b32 s56, s32, 13
    v_lshrrev_b32 v177, 3, v172
    v_and_b32 v178, 7, v172
    v_xor_b32 v178, v178, v174
    v_lshlrev_b32 v178, 4, v178
    v_lshl_add_u32 v179, v177, 10, v178
    s_lshl_b32 s63, s34, 6
    v_xor_b32 v26, s63, v179
    v_xor_b32 v27, 64, v26
    v_and_b32 v178, 7, v172
    v_lshlrev_b32 v179, 1, v174
    v_xor_b32 v178, v178, v179
    v_lshlrev_b32 v178, 4, v178
    v_lshl_add_u32 v178, v177, 10, v178
    s_lshl_b32 s63, s34, 16
    v_add_u32 v29, s63, v178
    v_lshlrev_b32 v177, 2, v174
    v_xor_b32 v177, v177, v173
    v_lshlrev_b32 v177, 4, v177
    v_lshl_add_u32 v177, v174, 13, v177
    s_lshl_b32 s63, s34, 17
    v_add_u32 v28, s63, v177
    s_waitcnt lgkmcnt(0)
    s_cmp_eq_u32 s46, 0
    s_cselect_b64 s[8:9], s[64:65], s[74:75]
    s_cselect_b64 s[16:17], s[66:67], s[76:77]
    s_cselect_b64 s[20:21], s[68:69], s[78:79]
    s_cselect_b64 s[12:13], s[70:71], s[80:81]
    s_cselect_b64 s[24:25], s[72:73], s[82:83]
    s_mul_i32 s63, s47, 163840
    s_add_u32 s8, s8, s63
    s_addc_u32 s9, s9, 0
    s_and_b32 s9, s9, 0xffff
    s_mov_b32 s11, 0x20000
    s_lshl_b32 s43, s45, 1
    s_add_u32 s43, s43, s33
    s_lshl_b32 s43, s43, 1
    s_lshl_b32 s63, s43, 8
    s_add_u32 s12, s12, s63
    s_addc_u32 s13, s13, 0
    s_and_b32 s13, s13, 0xffff
    s_mov_b32 s15, 0x20000
    s_sub_u32 s53, 0x400000, s63
    s_mov_b32 s35, 0
    s_and_b32 s99, s45, 0
    s_mov_b32 s98, s99
    s_mov_b32 s100, 1
    s_mul_i32 s101, s99, 96
    s_add_u32 s101, s101, 3
    s_mov_b32 s92, s47
    s_mov_b32 s93, s45
    s_mov_b32 s94, s43
    s_mov_b32 s95, s44
    s_mov_b32 s96, s48
    s_mov_b32 s97, s49
    s_mov_b32 s10, 163840
    s_mov_b32 s14, s53
    s_lshl_b32 s40, s62, 7
    s_add_u32 s40, s40, s52
    s_lshl_b32 s41, s62, 19
    s_lshl_b32 s63, s98, 8
    s_add_u32 s41, s41, s63
    s_add_u32 m0, s51, 0
    s_add_u32 s46, s40, 0
    buffer_load_dwordx4 v26, s[8:11], s46 offen offset:0 lds
    s_add_u32 s46, s40, 7168
    buffer_load_dwordx4 v27, s[8:11], s46 offen offset:1024 lds
    s_add_u32 s46, s40, 14336
    buffer_load_dwordx4 v26, s[8:11], s46 offen offset:2048 lds
    s_add_u32 s46, s40, 21504
    buffer_load_dwordx4 v27, s[8:11], s46 offen offset:3072 lds
    s_add_u32 m0, s51, 4096
    s_add_u32 s46, s40, 32768
    buffer_load_dwordx4 v26, s[8:11], s46 offen offset:0 lds
    s_add_u32 s63, s40, 128
    s_andn2_b32 s40, s63, 1024
    s_add_u32 m0, s50, 0
    s_add_u32 s42, s41, 0
    buffer_load_dwordx4 v28, s[12:15], s42 offen offset:0 lds
    s_add_u32 s42, s41, 31744
    buffer_load_dwordx4 v28, s[12:15], s42 offen offset:1024 lds
    s_add_u32 s42, s41, 63488
    buffer_load_dwordx4 v28, s[12:15], s42 offen offset:2048 lds
    s_add_u32 s42, s41, 95232
    buffer_load_dwordx4 v28, s[12:15], s42 offen offset:3072 lds
    s_add_u32 s41, s41, 262144
    s_and_b32 s41, s41, 0x3fffff
    s_lshl_b32 s63, s92, 5
    s_add_u32 s63, s63, s94
    s_lshl_b32 s63, s63, 17
    s_add_u32 s16, s16, s63
    s_addc_u32 s17, s17, 0
    s_and_b32 s17, s17, 0xffff
    s_mov_b32 s19, 0x20000
    s_add_u32 s20, s20, s63
    s_addc_u32 s21, s21, 0
    s_and_b32 s21, s21, 0xffff
    s_mov_b32 s23, 0x20000
    s_mov_b32 s18, 262144
    s_mov_b32 s22, 262144
    s_lshl_b32 s63, s93, 19
    s_add_u32 s24, s24, s63
    s_addc_u32 s25, s25, 0
    s_and_b32 s25, s25, 0xffff
    s_mov_b32 s27, 0x20000
    s_mov_b32 s26, 0x80000
    s_mov_b64 s[28:29], s[88:89]
    s_lshl_b32 s63, s95, 3
    s_add_u32 s63, s63, s93
    s_mul_i32 s63, s63, 163840
    s_add_u32 s28, s28, s63
    s_addc_u32 s29, s29, 0
    s_and_b32 s29, s29, 0xffff
    s_mov_b32 s31, 0x20000
    s_mov_b32 s30, 0
    s_cmp_eq_u32 s34, 1
    s_cselect_b64 s[4:5], s[20:21], s[16:17]
    s_load_dword s3, s[4:5], 0x0
    s_load_dword s3, s[4:5], 0x20000
    s_cselect_b64 s[6:7], s[24:25], s[28:29]
    s_mul_i32 s63, s92, 327680
    s_add_u32 s4, s84, s63
    s_addc_u32 s5, s85, 0
    s_cmp_eq_u32 s32, 3
    s_cselect_b64 s[6:7], s[4:5], s[6:7]
    s_add_u32 s4, s88, 50331648
    s_addc_u32 s5, s89, 0
    s_cmp_eq_u32 s32, 2
    s_cselect_b64 s[6:7], s[4:5], s[6:7]
    s_load_dword s3, s[6:7], 0
    s_cbranch_scc0 L_pf1
    s_load_dword s3, s[86:87], 0
L_pf1:
    s_lshl_b32 s66, s33, 18
    s_add_u32 s67, s66, 0x20000
    s_lshl_b32 s59, s92, 0
    s_add_u32 s59, s59, s93
    s_lshl_b32 s59, s59, 7
    s_add_u32 s59, s59, 128
    s_and_b32 s59, s59, 1023
    s_add_u32 s57, s66, s59
    s_add_u32 s58, s67, s59
    s_mov_b32 s54, 0x3e0293ee
    s_mov_b32 s55, 0x3e0293ee
    s_mov_b32 s61, 0
    s_mul_i32 s63, s34, 10240
    s_add_u32 s63, s63, 24576
    v_lshrrev_b32 v177, 1, v173
    v_xor_b32 v177, v177, v174
    v_lshlrev_b32 v177, 4, v177
    v_lshl_add_u32 v177, v173, 7, v177
    v_add_u32 v20, s63, v177
    v_xor_b32 v21, 64, v20
    v_lshl_add_u32 v177, v174, 3, v175
    v_lshl_add_u32 v178, v175, 2, v176
    v_lshlrev_b32 v178, 4, v178
    v_lshl_add_u32 v177, v177, 8, v178
    v_add_u32 v22, s97, v177
    v_xor_b32 v23, 64, v22
    v_xor_b32 v24, 128, v22
    v_xor_b32 v25, 192, v22
    s_lshl_b32 s63, s34, 12
    v_add_u32 v179, 0, v174
    v_and_b32 v177, 7, v179
    v_lshrrev_b32 v178, 3, v179
    v_lshlrev_b32 v177, 1, v177
    v_mul_u32_u24 v178, 9, v178
    v_xor_b32 v180, v177, v178
    v_xor_b32 v180, v180, v173
    v_lshlrev_b32 v180, 4, v180
    v_lshl_add_u32 v180, v174, 8, v180
    v_add_u32 v16, s63, v180
    v_add_u32 v179, 4, v174
    v_and_b32 v177, 7, v179
    v_lshrrev_b32 v178, 3, v179
    v_lshlrev_b32 v177, 1, v177
    v_mul_u32_u24 v178, 9, v178
    v_xor_b32 v180, v177, v178
    v_xor_b32 v180, v180, v173
    v_lshlrev_b32 v180, 4, v180
    v_lshl_add_u32 v180, v174, 8, v180
    v_add_u32 v17, s63, v180
    v_add_u32 v179, 8, v174
    v_and_b32 v177, 7, v179
    v_lshrrev_b32 v178, 3, v179
    v_lshlrev_b32 v177, 1, v177
    v_mul_u32_u24 v178, 9, v178
    v_xor_b32 v180, v177, v178
    v_xor_b32 v180, v180, v173
    v_lshlrev_b32 v180, 4, v180
    v_lshl_add_u32 v180, v174, 8, v180
    v_add_u32 v18, s63, v180
    v_add_u32 v179, 12, v174
    v_and_b32 v177, 7, v179
    v_lshrrev_b32 v178, 3, v179
    v_lshlrev_b32 v177, 1, v177
    v_mul_u32_u24 v178, 9, v178
    v_xor_b32 v180, v177, v178
    v_xor_b32 v180, v180, v173
    v_lshlrev_b32 v180, 4, v180
    v_lshl_add_u32 v180, v174, 8, v180
    v_add_u32 v19, s63, v180
    v_and_b32 v177, 7, v173
    v_lshrrev_b32 v178, 3, v173
    v_lshlrev_b32 v177, 1, v177
    v_mul_u32_u24 v178, 9, v178
    v_xor_b32 v180, v177, v178
    v_xor_b32 v180, v180, v174
    v_lshlrev_b32 v180, 4, v180
    v_lshl_add_u32 v180, v173, 8, v180
    v_add_u32 v4, s96, v180
    v_xor_b32 v5, 64, v4
    v_xor_b32 v6, 128, v4
    v_xor_b32 v7, 192, v4
    v_lshl_add_u32 v182, v174, 2, v175
    v_and_b32 v177, 7, v182
    v_lshrrev_b32 v178, 3, v182
    v_lshlrev_b32 v177, 1, v177
    v_mul_u32_u24 v178, 9, v178
    v_xor_b32 v181, v177, v178
    v_lshrrev_b32 v177, 1, v176
    v_xor_b32 v181, v181, v177
    v_lshlrev_b32 v181, 4, v181
    v_lshl_add_u32 v181, v182, 8, v181
    v_and_b32 v178, 1, v176
    v_lshl_add_u32 v181, v178, 3, v181
    s_add_u32 s63, s96, 8192
    v_add_u32 v8, s63, v181
    v_xor_b32 v9, 32, v8
    v_xor_b32 v10, 64, v8
    v_xor_b32 v11, 96, v8
    v_xor_b32 v12, 128, v8
    v_xor_b32 v13, 160, v8
    v_xor_b32 v14, 192, v8
    v_xor_b32 v15, 224, v8
    v_and_b32 v179, 6, v182
    v_xor_b32 v179, v179, v177
    v_lshlrev_b32 v179, 4, v179
    v_lshl_add_u32 v179, v182, 7, v179
    v_lshl_add_u32 v179, v178, 3, v179
    s_lshl_b32 s63, s33, 6
    v_xor_b32 v179, s63, v179
    s_lshl_b32 s63, s33, 14
    v_add_u32 v252, s63, v179
    v_xor_b32 v253, 32, v252
    v_lshlrev_b32 v30, 4, v172
    v_lshlrev_b32 v31, 2, v0
    v_add_u32 v31, 155648, v31
    v_and_b32 v254, 3, v0
    v_lshlrev_b32 v254, 6, v254
    v_add_u32 v254, v254, v172
    v_lshlrev_b32 v254, 2, v254
    v_add_u32 v254, 155648, v254
    v_mov_b32 v32, 0x3f803f80
    v_mov_b32 v33, 0x3f803f80
    v_mov_b32 v34, 0x3f803f80
    v_mov_b32 v35, 0x3f803f80
    s_add_u32 m0, s50, 8192
    s_add_u32 s42, s41, 0
    buffer_load_dwordx4 v28, s[12:15], s42 offen offset:0 lds
    s_add_u32 s42, s41, 31744
    buffer_load_dwordx4 v28, s[12:15], s42 offen offset:1024 lds
    s_add_u32 s42, s41, 63488
    buffer_load_dwordx4 v28, s[12:15], s42 offen offset:2048 lds
    s_add_u32 s42, s41, 95232
    buffer_load_dwordx4 v28, s[12:15], s42 offen offset:3072 lds
    s_add_u32 s41, s41, 262144
    s_and_b32 s41, s41, 0x3fffff
    s_mov_b32 s96, s95
    s_mov_b32 s97, s93
    s_mov_b64 s[84:85], s[86:87]
    s_and_b32 s85, s85, 0xffff
    s_mov_b32 s86, 256
    s_mov_b32 s87, 0x20000
    s_add_u32 s92, s88, 50331648
    s_addc_u32 s93, s89, 0
    s_and_b32 s93, s93, 0xffff
    s_lshl_b32 s63, s96, 3
    v_mov_b32 v3, s63
    s_add_u32 s63, s63, s97
    s_lshl_b32 s63, s63, 7
    v_mov_b32 v1, s63
    v_cmp_eq_u32 vcc, 0, v0
    v_mov_b32 v177, 0x7ff00000
    v_mov_b32 v2, 0
    v_cndmask_b32 v3, v177, v3, vcc
    v_cndmask_b32 v1, v177, v1, vcc
    s_mov_b64 s[4:5], s[92:93]
    s_mov_b32 s6, 32768
    s_mov_b32 s7, 0x20000
    s_lshl_b32 s63, 1, s97
    v_mov_b32 v255, s63
L_q:
    s_waitcnt vmcnt(4) lgkmcnt(0)
    s_barrier
    ds_read_b64_tr_b16 v[36:37], v22 offset:0
    ds_read_b64_tr_b16 v[38:39], v22 offset:1024
    ds_read_b128 v[52:55], v20 offset:0
    ds_read_b128 v[56:59], v20 offset:2048
    ds_read_b128 v[60:63], v20 offset:4096
    ds_read_b128 v[64:67], v20 offset:6144
    ds_read_b128 v[68:71], v20 offset:8192
    ds_read_b64_tr_b16 v[40:41], v22 offset:8
    ds_read_b64_tr_b16 v[42:43], v22 offset:1032
    ds_read_b64_tr_b16 v[44:45], v23 offset:0
    ds_read_b64_tr_b16 v[46:47], v23 offset:1024
    ds_read_b64_tr_b16 v[48:49], v23 offset:8
    ds_read_b64_tr_b16 v[50:51], v23 offset:1032
    s_waitcnt lgkmcnt(6)
    s_mov_b32 s36, 0
    v_mfma_f32_16x16x32_bf16 v[92:95], v[36:39], v[52:55], 0
    s_add_u32 m0, s51, 20480
    s_add_u32 s46, s40, 0
    buffer_load_dwordx4 v26, s[8:11], s46 offen offset:0 lds
    v_mfma_f32_16x16x32_bf16 v[100:103], v[36:39], v[56:59], 0
    s_add_u32 s46, s40, 7168
    buffer_load_dwordx4 v27, s[8:11], s46 offen offset:1024 lds
    v_mfma_f32_16x16x32_bf16 v[108:111], v[36:39], v[60:63], 0
    v_mfma_f32_16x16x32_bf16 v[116:119], v[36:39], v[64:67], 0
    s_add_u32 s46, s40, 14336
    buffer_load_dwordx4 v26, s[8:11], s46 offen offset:2048 lds
    v_mfma_f32_16x16x32_bf16 v[124:127], v[36:39], v[68:71], 0
    s_waitcnt lgkmcnt(4)
    ds_read_b64_tr_b16 a[240:241], v24 offset:0
    ds_read_b64_tr_b16 a[242:243], v24 offset:1024
    v_mfma_f32_16x16x32_bf16 v[96:99], v[40:43], v[52:55], 0
    v_mfma_f32_16x16x32_bf16 v[104:107], v[40:43], v[56:59], 0
    s_add_u32 s46, s40, 21504
    buffer_load_dwordx4 v27, s[8:11], s46 offen offset:3072 lds
    v_mfma_f32_16x16x32_bf16 v[112:115], v[40:43], v[60:63], 0
    s_add_u32 m0, s51, 24576
    s_add_u32 s46, s40, 32768
    buffer_load_dwordx4 v26, s[8:11], s46 offen offset:0 lds
    v_mfma_f32_16x16x32_bf16 v[120:123], v[40:43], v[64:67], 0
    v_mfma_f32_16x16x32_bf16 v[128:131], v[40:43], v[68:71], 0
    s_waitcnt lgkmcnt(4)
    ds_read_b64_tr_b16 a[244:245], v24 offset:8
    ds_read_b64_tr_b16 a[246:247], v24 offset:1032
    v_mfma_f32_16x16x32_bf16 v[132:135], v[44:47], v[52:55], 0
    s_add_u32 s63, s40, 128
    s_andn2_b32 s40, s63, 1024
    s_add_u32 m0, s50, 16384
    s_add_u32 s42, s41, 0
    buffer_load_dwordx4 v28, s[12:15], s42 offen offset:0 lds
    v_mfma_f32_16x16x32_bf16 v[140:143], v[44:47], v[56:59], 0
    v_mfma_f32_16x16x32_bf16 v[148:151], v[44:47], v[60:63], 0
    s_add_u32 s42, s41, 31744
    buffer_load_dwordx4 v28, s[12:15], s42 offen offset:1024 lds
    v_mfma_f32_16x16x32_bf16 v[156:159], v[44:47], v[64:67], 0
    s_add_u32 s42, s41, 63488
    buffer_load_dwordx4 v28, s[12:15], s42 offen offset:2048 lds
    v_mfma_f32_16x16x32_bf16 v[164:167], v[44:47], v[68:71], 0
    s_waitcnt lgkmcnt(4)
    ds_read_b64_tr_b16 a[248:249], v25 offset:0
    ds_read_b64_tr_b16 a[250:251], v25 offset:1024
    v_mfma_f32_16x16x32_bf16 v[136:139], v[48:51], v[52:55], 0
    v_mfma_f32_16x16x32_bf16 v[144:147], v[48:51], v[56:59], 0
    s_add_u32 s42, s41, 95232
    buffer_load_dwordx4 v28, s[12:15], s42 offen offset:3072 lds
    v_mfma_f32_16x16x32_bf16 v[152:155], v[48:51], v[60:63], 0
    v_mfma_f32_16x16x32_bf16 v[160:163], v[48:51], v[64:67], 0
    s_add_u32 s41, s41, 262144
    s_and_b32 s41, s41, 0x3fffff
    s_add_u32 m0, s50, 24576
    s_add_u32 s42, s41, 0
    buffer_load_dwordx4 v28, s[12:15], s42 offen offset:0 lds
    v_mfma_f32_16x16x32_bf16 v[168:171], v[48:51], v[68:71], 0
    s_waitcnt lgkmcnt(4)
    ds_read_b64_tr_b16 a[252:253], v25 offset:8
    ds_read_b64_tr_b16 a[254:255], v25 offset:1032
    v_mfma_f32_16x16x32_bf16 v[172:175], a[240:243], v[52:55], 0
    s_add_u32 s42, s41, 31744
    buffer_load_dwordx4 v28, s[12:15], s42 offen offset:1024 lds
    v_mfma_f32_16x16x32_bf16 v[180:183], a[240:243], v[56:59], 0
    v_mfma_f32_16x16x32_bf16 v[188:191], a[240:243], v[60:63], 0
    s_add_u32 s42, s41, 63488
    buffer_load_dwordx4 v28, s[12:15], s42 offen offset:2048 lds
    v_mfma_f32_16x16x32_bf16 v[196:199], a[240:243], v[64:67], 0
    v_mfma_f32_16x16x32_bf16 v[204:207], a[240:243], v[68:71], 0
    s_waitcnt lgkmcnt(4)
    s_add_u32 s42, s41, 95232
    buffer_load_dwordx4 v28, s[12:15], s42 offen offset:3072 lds
    v_mfma_f32_16x16x32_bf16 v[176:179], a[244:247], v[52:55], 0
    s_add_u32 s41, s41, 262144
    s_and_b32 s41, s41, 0x3fffff
    v_mfma_f32_16x16x32_bf16 v[184:187], a[244:247], v[56:59], 0
    s_waitcnt vmcnt(13) lgkmcnt(0)
    s_barrier
    v_mfma_f32_16x16x32_bf16 v[192:195], a[244:247], v[60:63], 0
    s_add_u32 m0, s50, 0
    ds_read_b64_tr_b16 v[36:37], v22 offset:8192
    ds_read_b64_tr_b16 v[38:39], v22 offset:9216
    v_mfma_f32_16x16x32_bf16 v[200:203], a[244:247], v[64:67], 0
    s_add_u32 s42, s41, 0
    ds_read_b128 v[72:75], v21 offset:0
    ds_read_b128 v[76:79], v21 offset:2048
    v_mfma_f32_16x16x32_bf16 v[208:211], a[244:247], v[68:71], 0
    ds_read_b128 v[80:83], v21 offset:4096
    ds_read_b128 v[84:87], v21 offset:6144
    v_mfma_f32_16x16x32_bf16 v[212:215], a[248:251], v[52:55], 0
    ds_read_b128 v[88:91], v21 offset:8192
    ds_read_b64_tr_b16 v[40:41], v22 offset:8200
    v_mfma_f32_16x16x32_bf16 v[220:223], a[248:251], v[56:59], 0
    ds_read_b64_tr_b16 v[42:43], v22 offset:9224
    v_mfma_f32_16x16x32_bf16 v[228:231], a[248:251], v[60:63], 0
    v_mfma_f32_16x16x32_bf16 v[236:239], a[248:251], v[64:67], 0
    v_mfma_f32_16x16x32_bf16 v[244:247], a[248:251], v[68:71], 0
    ds_read_b64_tr_b16 v[44:45], v23 offset:8192
    ds_read_b64_tr_b16 v[46:47], v23 offset:9216
    v_mfma_f32_16x16x32_bf16 v[216:219], a[252:255], v[52:55], 0
    s_add_u32 s43, s41, 31744
    buffer_load_dwordx4 v28, s[12:15], s42 offen offset:0 lds
    v_mfma_f32_16x16x32_bf16 v[224:227], a[252:255], v[56:59], 0
    v_mfma_f32_16x16x32_bf16 v[232:235], a[252:255], v[60:63], 0
    v_mfma_f32_16x16x32_bf16 v[240:243], a[252:255], v[64:67], 0
    v_mfma_f32_16x16x32_bf16 v[248:251], a[252:255], v[68:71], 0
    s_waitcnt lgkmcnt(4)
    ds_read_b64_tr_b16 v[48:49], v23 offset:8200
    ds_read_b64_tr_b16 v[50:51], v23 offset:9224
.p2align 3
L_qloop:
    v_mfma_f32_16x16x32_bf16 v[92:95], v[36:39], v[72:75], v[92:95]
    v_mfma_f32_16x16x32_bf16 v[100:103], v[36:39], v[76:79], v[100:103]
    v_mfma_f32_16x16x32_bf16 v[108:111], v[36:39], v[80:83], v[108:111]
    s_add_u32 s42, s41, 63488
    buffer_load_dwordx4 v28, s[12:15], s43 offen offset:1024 lds
    v_mfma_f32_16x16x32_bf16 v[116:119], v[36:39], v[84:87], v[116:119]
    v_mfma_f32_16x16x32_bf16 v[124:127], v[36:39], v[88:91], v[124:127]
    s_waitcnt lgkmcnt(4)
    ds_read_b64_tr_b16 a[240:241], v24 offset:8192
    ds_read_b64_tr_b16 a[242:243], v24 offset:9216
    v_mfma_f32_16x16x32_bf16 v[96:99], v[40:43], v[72:75], v[96:99]
    v_mfma_f32_16x16x32_bf16 v[104:107], v[40:43], v[76:79], v[104:107]
    v_mfma_f32_16x16x32_bf16 v[112:115], v[40:43], v[80:83], v[112:115]
    v_mfma_f32_16x16x32_bf16 v[120:123], v[40:43], v[84:87], v[120:123]
    v_mfma_f32_16x16x32_bf16 v[128:131], v[40:43], v[88:91], v[128:131]
    s_waitcnt lgkmcnt(4)
    ds_read_b64_tr_b16 a[244:245], v24 offset:8200
    ds_read_b64_tr_b16 a[246:247], v24 offset:9224
    v_mfma_f32_16x16x32_bf16 v[132:135], v[44:47], v[72:75], v[132:135]
    s_add_u32 s43, s41, 95232
    buffer_load_dwordx4 v28, s[12:15], s42 offen offset:2048 lds
    v_mfma_f32_16x16x32_bf16 v[140:143], v[44:47], v[76:79], v[140:143]
    s_add_u32 s41, s41, 262144
    v_mfma_f32_16x16x32_bf16 v[148:151], v[44:47], v[80:83], v[148:151]
    s_and_b32 s41, s41, 0x3fffff
    v_mfma_f32_16x16x32_bf16 v[156:159], v[44:47], v[84:87], v[156:159]
    v_mfma_f32_16x16x32_bf16 v[164:167], v[44:47], v[88:91], v[164:167]
    s_waitcnt lgkmcnt(4)
    ds_read_b64_tr_b16 a[248:249], v25 offset:8192
    ds_read_b64_tr_b16 a[250:251], v25 offset:9216
    v_mfma_f32_16x16x32_bf16 v[136:139], v[48:51], v[72:75], v[136:139]
    v_mfma_f32_16x16x32_bf16 v[144:147], v[48:51], v[76:79], v[144:147]
    buffer_load_dwordx4 v28, s[12:15], s43 offen offset:3072 lds
    v_mfma_f32_16x16x32_bf16 v[152:155], v[48:51], v[80:83], v[152:155]
    v_mfma_f32_16x16x32_bf16 v[160:163], v[48:51], v[84:87], v[160:163]
    v_mfma_f32_16x16x32_bf16 v[168:171], v[48:51], v[88:91], v[168:171]
    s_waitcnt lgkmcnt(4)
    ds_read_b64_tr_b16 a[252:253], v25 offset:8200
    v_mfma_f32_16x16x32_bf16 v[172:175], a[240:243], v[72:75], v[172:175]
    ds_read_b64_tr_b16 a[254:255], v25 offset:9224
    v_mfma_f32_16x16x32_bf16 v[180:183], a[240:243], v[76:79], v[180:183]
    v_mfma_f32_16x16x32_bf16 v[188:191], a[240:243], v[80:83], v[188:191]
    v_mfma_f32_16x16x32_bf16 v[196:199], a[240:243], v[84:87], v[196:199]
    v_mfma_f32_16x16x32_bf16 v[204:207], a[240:243], v[88:91], v[204:207]
    s_waitcnt lgkmcnt(4)
    v_mfma_f32_16x16x32_bf16 v[176:179], a[244:247], v[72:75], v[176:179]
    v_mfma_f32_16x16x32_bf16 v[184:187], a[244:247], v[76:79], v[184:187]
    s_waitcnt vmcnt(8) lgkmcnt(0)
    s_barrier
    v_mfma_f32_16x16x32_bf16 v[192:195], a[244:247], v[80:83], v[192:195]
    s_add_u32 m0, s51, 0
    ds_read_b64_tr_b16 v[36:37], v22 offset:16384
    ds_read_b64_tr_b16 v[38:39], v22 offset:17408
    v_mfma_f32_16x16x32_bf16 v[200:203], a[244:247], v[84:87], v[200:203]
    s_add_u32 s46, s40, 0
    ds_read_b128 v[52:55], v20 offset:20480
    ds_read_b128 v[56:59], v20 offset:22528
    v_mfma_f32_16x16x32_bf16 v[208:211], a[244:247], v[88:91], v[208:211]
    ds_read_b128 v[60:63], v20 offset:24576
    ds_read_b128 v[64:67], v20 offset:26624
    v_mfma_f32_16x16x32_bf16 v[212:215], a[248:251], v[72:75], v[212:215]
    ds_read_b128 v[68:71], v20 offset:28672
    ds_read_b64_tr_b16 v[40:41], v22 offset:16392
    v_mfma_f32_16x16x32_bf16 v[220:223], a[248:251], v[76:79], v[220:223]
    ds_read_b64_tr_b16 v[42:43], v22 offset:17416
    v_mfma_f32_16x16x32_bf16 v[228:231], a[248:251], v[80:83], v[228:231]
    s_add_u32 s47, s40, 7168
    buffer_load_dwordx4 v26, s[8:11], s46 offen offset:0 lds
    v_mfma_f32_16x16x32_bf16 v[236:239], a[248:251], v[84:87], v[236:239]
    s_add_u32 s46, s40, 14336
    buffer_load_dwordx4 v27, s[8:11], s47 offen offset:1024 lds
    v_mfma_f32_16x16x32_bf16 v[244:247], a[248:251], v[88:91], v[244:247]
    ds_read_b64_tr_b16 v[44:45], v23 offset:16384
    ds_read_b64_tr_b16 v[46:47], v23 offset:17408
    v_mfma_f32_16x16x32_bf16 v[216:219], a[252:255], v[72:75], v[216:219]
    v_mfma_f32_16x16x32_bf16 v[224:227], a[252:255], v[76:79], v[224:227]
    s_add_u32 s47, s40, 21504
    buffer_load_dwordx4 v26, s[8:11], s46 offen offset:2048 lds
    v_mfma_f32_16x16x32_bf16 v[232:235], a[252:255], v[80:83], v[232:235]
    v_mfma_f32_16x16x32_bf16 v[240:243], a[252:255], v[84:87], v[240:243]
    v_mfma_f32_16x16x32_bf16 v[248:251], a[252:255], v[88:91], v[248:251]
    s_waitcnt lgkmcnt(4)
    ds_read_b64_tr_b16 v[48:49], v23 offset:16392
    ds_read_b64_tr_b16 v[50:51], v23 offset:17416
    v_mfma_f32_16x16x32_bf16 v[92:95], v[36:39], v[52:55], v[92:95]
    buffer_load_dwordx4 v27, s[8:11], s47 offen offset:3072 lds
    v_mfma_f32_16x16x32_bf16 v[100:103], v[36:39], v[56:59], v[100:103]
    s_add_u32 m0, s51, 4096
    s_add_u32 s46, s40, 32768
    v_mfma_f32_16x16x32_bf16 v[108:111], v[36:39], v[60:63], v[108:111]
    v_mfma_f32_16x16x32_bf16 v[116:119], v[36:39], v[64:67], v[116:119]
    v_mfma_f32_16x16x32_bf16 v[124:127], v[36:39], v[68:71], v[124:127]
    s_waitcnt lgkmcnt(4)
    ds_read_b64_tr_b16 a[240:241], v24 offset:16384
    ds_read_b64_tr_b16 a[242:243], v24 offset:17408
    v_mfma_f32_16x16x32_bf16 v[96:99], v[40:43], v[52:55], v[96:99]
    buffer_load_dwordx4 v26, s[8:11], s46 offen offset:0 lds
    v_mfma_f32_16x16x32_bf16 v[104:107], v[40:43], v[56:59], v[104:107]
    s_add_u32 m0, s50, 8192
    s_add_u32 s42, s41, 0
    s_add_u32 s63, s40, 128
    v_mfma_f32_16x16x32_bf16 v[112:115], v[40:43], v[60:63], v[112:115]
    s_andn2_b32 s40, s63, 1024
    v_mfma_f32_16x16x32_bf16 v[120:123], v[40:43], v[64:67], v[120:123]
    s_add_u32 s43, s41, 31744
    buffer_load_dwordx4 v28, s[12:15], s42 offen offset:0 lds
    v_mfma_f32_16x16x32_bf16 v[128:131], v[40:43], v[68:71], v[128:131]
    s_waitcnt lgkmcnt(4)
    ds_read_b64_tr_b16 a[244:245], v24 offset:16392
    ds_read_b64_tr_b16 a[246:247], v24 offset:17416
    v_mfma_f32_16x16x32_bf16 v[132:135], v[44:47], v[52:55], v[132:135]
    v_mfma_f32_16x16x32_bf16 v[140:143], v[44:47], v[56:59], v[140:143]
    v_mfma_f32_16x16x32_bf16 v[148:151], v[44:47], v[60:63], v[148:151]
    s_add_u32 s42, s41, 63488
    buffer_load_dwordx4 v28, s[12:15], s43 offen offset:1024 lds
    v_mfma_f32_16x16x32_bf16 v[156:159], v[44:47], v[64:67], v[156:159]
    v_mfma_f32_16x16x32_bf16 v[164:167], v[44:47], v[68:71], v[164:167]
    s_waitcnt lgkmcnt(4)
    ds_read_b64_tr_b16 a[248:249], v25 offset:16384
    ds_read_b64_tr_b16 a[250:251], v25 offset:17408
    v_mfma_f32_16x16x32_bf16 v[136:139], v[48:51], v[52:55], v[136:139]
    v_mfma_f32_16x16x32_bf16 v[144:147], v[48:51], v[56:59], v[144:147]
    s_add_u32 s43, s41, 95232
    buffer_load_dwordx4 v28, s[12:15], s42 offen offset:2048 lds
    v_mfma_f32_16x16x32_bf16 v[152:155], v[48:51], v[60:63], v[152:155]
    s_add_u32 s41, s41, 262144
    v_mfma_f32_16x16x32_bf16 v[160:163], v[48:51], v[64:67], v[160:163]
    s_and_b32 s41, s41, 0x3fffff
    v_mfma_f32_16x16x32_bf16 v[168:171], v[48:51], v[68:71], v[168:171]
    s_waitcnt lgkmcnt(4)
    ds_read_b64_tr_b16 a[252:253], v25 offset:16392
    ds_read_b64_tr_b16 a[254:255], v25 offset:17416
    v_mfma_f32_16x16x32_bf16 v[172:175], a[240:243], v[52:55], v[172:175]
    buffer_load_dwordx4 v28, s[12:15], s43 offen offset:3072 lds
    v_mfma_f32_16x16x32_bf16 v[180:183], a[240:243], v[56:59], v[180:183]
    v_mfma_f32_16x16x32_bf16 v[188:191], a[240:243], v[60:63], v[188:191]
    v_mfma_f32_16x16x32_bf16 v[196:199], a[240:243], v[64:67], v[196:199]
    v_mfma_f32_16x16x32_bf16 v[204:207], a[240:243], v[68:71], v[204:207]
    s_waitcnt lgkmcnt(4)
    v_mfma_f32_16x16x32_bf16 v[176:179], a[244:247], v[52:55], v[176:179]
    v_mfma_f32_16x16x32_bf16 v[184:187], a[244:247], v[56:59], v[184:187]
    s_waitcnt vmcnt(13) lgkmcnt(0)
    s_barrier
    v_mfma_f32_16x16x32_bf16 v[192:195], a[244:247], v[60:63], v[192:195]
    s_add_u32 m0, s50, 16384
    ds_read_b64_tr_b16 v[36:37], v22 offset:24576
    ds_read_b64_tr_b16 v[38:39], v22 offset:25600
    v_mfma_f32_16x16x32_bf16 v[200:203], a[244:247], v[64:67], v[200:203]
    s_add_u32 s42, s41, 0
    ds_read_b128 v[72:75], v21 offset:20480
    ds_read_b128 v[76:79], v21 offset:22528
    v_mfma_f32_16x16x32_bf16 v[208:211], a[244:247], v[68:71], v[208:211]
    ds_read_b128 v[80:83], v21 offset:24576
    ds_read_b128 v[84:87], v21 offset:26624
    v_mfma_f32_16x16x32_bf16 v[212:215], a[248:251], v[52:55], v[212:215]
    ds_read_b128 v[88:91], v21 offset:28672
    ds_read_b64_tr_b16 v[40:41], v22 offset:24584
    v_mfma_f32_16x16x32_bf16 v[220:223], a[248:251], v[56:59], v[220:223]
    ds_read_b64_tr_b16 v[42:43], v22 offset:25608
    v_mfma_f32_16x16x32_bf16 v[228:231], a[248:251], v[60:63], v[228:231]
    v_mfma_f32_16x16x32_bf16 v[236:239], a[248:251], v[64:67], v[236:239]
    v_mfma_f32_16x16x32_bf16 v[244:247], a[248:251], v[68:71], v[244:247]
    ds_read_b64_tr_b16 v[44:45], v23 offset:24576
    ds_read_b64_tr_b16 v[46:47], v23 offset:25600
    v_mfma_f32_16x16x32_bf16 v[216:219], a[252:255], v[52:55], v[216:219]
    s_add_u32 s43, s41, 31744
    buffer_load_dwordx4 v28, s[12:15], s42 offen offset:0 lds
    v_mfma_f32_16x16x32_bf16 v[224:227], a[252:255], v[56:59], v[224:227]
    v_mfma_f32_16x16x32_bf16 v[232:235], a[252:255], v[60:63], v[232:235]
    v_mfma_f32_16x16x32_bf16 v[240:243], a[252:255], v[64:67], v[240:243]
    v_mfma_f32_16x16x32_bf16 v[248:251], a[252:255], v[68:71], v[248:251]
    s_waitcnt lgkmcnt(4)
    ds_read_b64_tr_b16 v[48:49], v23 offset:24584
    ds_read_b64_tr_b16 v[50:51], v23 offset:25608
    s_cmp_eq_u32 s36, 3
    s_cbranch_scc1 L_qdone
    v_mfma_f32_16x16x32_bf16 v[92:95], v[36:39], v[72:75], v[92:95]
    v_mfma_f32_16x16x32_bf16 v[100:103], v[36:39], v[76:79], v[100:103]
    v_mfma_f32_16x16x32_bf16 v[108:111], v[36:39], v[80:83], v[108:111]
    s_add_u32 s42, s41, 63488
    buffer_load_dwordx4 v28, s[12:15], s43 offen offset:1024 lds
    v_mfma_f32_16x16x32_bf16 v[116:119], v[36:39], v[84:87], v[116:119]
    v_mfma_f32_16x16x32_bf16 v[124:127], v[36:39], v[88:91], v[124:127]
    s_waitcnt lgkmcnt(4)
    ds_read_b64_tr_b16 a[240:241], v24 offset:24576
    ds_read_b64_tr_b16 a[242:243], v24 offset:25600
    v_mfma_f32_16x16x32_bf16 v[96:99], v[40:43], v[72:75], v[96:99]
    v_mfma_f32_16x16x32_bf16 v[104:107], v[40:43], v[76:79], v[104:107]
    v_mfma_f32_16x16x32_bf16 v[112:115], v[40:43], v[80:83], v[112:115]
    v_mfma_f32_16x16x32_bf16 v[120:123], v[40:43], v[84:87], v[120:123]
    v_mfma_f32_16x16x32_bf16 v[128:131], v[40:43], v[88:91], v[128:131]
    s_waitcnt lgkmcnt(4)
    ds_read_b64_tr_b16 a[244:245], v24 offset:24584
    ds_read_b64_tr_b16 a[246:247], v24 offset:25608
    v_mfma_f32_16x16x32_bf16 v[132:135], v[44:47], v[72:75], v[132:135]
    s_add_u32 s43, s41, 95232
    buffer_load_dwordx4 v28, s[12:15], s42 offen offset:2048 lds
    v_mfma_f32_16x16x32_bf16 v[140:143], v[44:47], v[76:79], v[140:143]
    s_add_u32 s41, s41, 262144
    v_mfma_f32_16x16x32_bf16 v[148:151], v[44:47], v[80:83], v[148:151]
    s_and_b32 s41, s41, 0x3fffff
    v_mfma_f32_16x16x32_bf16 v[156:159], v[44:47], v[84:87], v[156:159]
    v_mfma_f32_16x16x32_bf16 v[164:167], v[44:47], v[88:91], v[164:167]
    s_waitcnt lgkmcnt(4)
    ds_read_b64_tr_b16 a[248:249], v25 offset:24576
    ds_read_b64_tr_b16 a[250:251], v25 offset:25600
    v_mfma_f32_16x16x32_bf16 v[136:139], v[48:51], v[72:75], v[136:139]
    v_mfma_f32_16x16x32_bf16 v[144:147], v[48:51], v[76:79], v[144:147]
    buffer_load_dwordx4 v28, s[12:15], s43 offen offset:3072 lds
    v_mfma_f32_16x16x32_bf16 v[152:155], v[48:51], v[80:83], v[152:155]
    v_mfma_f32_16x16x32_bf16 v[160:163], v[48:51], v[84:87], v[160:163]
    v_mfma_f32_16x16x32_bf16 v[168:171], v[48:51], v[88:91], v[168:171]
    s_waitcnt lgkmcnt(4)
    ds_read_b64_tr_b16 a[252:253], v25 offset:24584
    v_mfma_f32_16x16x32_bf16 v[172:175], a[240:243], v[72:75], v[172:175]
    ds_read_b64_tr_b16 a[254:255], v25 offset:25608
    v_mfma_f32_16x16x32_bf16 v[180:183], a[240:243], v[76:79], v[180:183]
    v_mfma_f32_16x16x32_bf16 v[188:191], a[240:243], v[80:83], v[188:191]
    v_mfma_f32_16x16x32_bf16 v[196:199], a[240:243], v[84:87], v[196:199]
    v_mfma_f32_16x16x32_bf16 v[204:207], a[240:243], v[88:91], v[204:207]
    s_waitcnt lgkmcnt(4)
    v_mfma_f32_16x16x32_bf16 v[176:179], a[244:247], v[72:75], v[176:179]
    v_mfma_f32_16x16x32_bf16 v[184:187], a[244:247], v[76:79], v[184:187]
    s_waitcnt vmcnt(8) lgkmcnt(0)
    s_barrier
    v_mfma_f32_16x16x32_bf16 v[192:195], a[244:247], v[80:83], v[192:195]
    s_add_u32 m0, s51, 20480
    ds_read_b64_tr_b16 v[36:37], v22 offset:0
    ds_read_b64_tr_b16 v[38:39], v22 offset:1024
    v_mfma_f32_16x16x32_bf16 v[200:203], a[244:247], v[84:87], v[200:203]
    s_add_u32 s46, s40, 0
    ds_read_b128 v[52:55], v20 offset:0
    ds_read_b128 v[56:59], v20 offset:2048
    v_mfma_f32_16x16x32_bf16 v[208:211], a[244:247], v[88:91], v[208:211]
    ds_read_b128 v[60:63], v20 offset:4096
    ds_read_b128 v[64:67], v20 offset:6144
    v_mfma_f32_16x16x32_bf16 v[212:215], a[248:251], v[72:75], v[212:215]
    ds_read_b128 v[68:71], v20 offset:8192
    ds_read_b64_tr_b16 v[40:41], v22 offset:8
    v_mfma_f32_16x16x32_bf16 v[220:223], a[248:251], v[76:79], v[220:223]
    ds_read_b64_tr_b16 v[42:43], v22 offset:1032
    v_mfma_f32_16x16x32_bf16 v[228:231], a[248:251], v[80:83], v[228:231]
    s_add_u32 s47, s40, 7168
    buffer_load_dwordx4 v26, s[8:11], s46 offen offset:0 lds
    v_mfma_f32_16x16x32_bf16 v[236:239], a[248:251], v[84:87], v[236:239]
    s_add_u32 s46, s40, 14336
    buffer_load_dwordx4 v27, s[8:11], s47 offen offset:1024 lds
    v_mfma_f32_16x16x32_bf16 v[244:247], a[248:251], v[88:91], v[244:247]
    ds_read_b64_tr_b16 v[44:45], v23 offset:0
    ds_read_b64_tr_b16 v[46:47], v23 offset:1024
    v_mfma_f32_16x16x32_bf16 v[216:219], a[252:255], v[72:75], v[216:219]
    v_mfma_f32_16x16x32_bf16 v[224:227], a[252:255], v[76:79], v[224:227]
    s_add_u32 s47, s40, 21504
    buffer_load_dwordx4 v26, s[8:11], s46 offen offset:2048 lds
    v_mfma_f32_16x16x32_bf16 v[232:235], a[252:255], v[80:83], v[232:235]
    v_mfma_f32_16x16x32_bf16 v[240:243], a[252:255], v[84:87], v[240:243]
    v_mfma_f32_16x16x32_bf16 v[248:251], a[252:255], v[88:91], v[248:251]
    s_waitcnt lgkmcnt(4)
    ds_read_b64_tr_b16 v[48:49], v23 offset:8
    ds_read_b64_tr_b16 v[50:51], v23 offset:1032
    v_mfma_f32_16x16x32_bf16 v[92:95], v[36:39], v[52:55], v[92:95]
    buffer_load_dwordx4 v27, s[8:11], s47 offen offset:3072 lds
    v_mfma_f32_16x16x32_bf16 v[100:103], v[36:39], v[56:59], v[100:103]
    s_add_u32 m0, s51, 24576
    s_add_u32 s46, s40, 32768
    v_mfma_f32_16x16x32_bf16 v[108:111], v[36:39], v[60:63], v[108:111]
    v_mfma_f32_16x16x32_bf16 v[116:119], v[36:39], v[64:67], v[116:119]
    v_mfma_f32_16x16x32_bf16 v[124:127], v[36:39], v[68:71], v[124:127]
    s_waitcnt lgkmcnt(4)
    ds_read_b64_tr_b16 a[240:241], v24 offset:0
    ds_read_b64_tr_b16 a[242:243], v24 offset:1024
    v_mfma_f32_16x16x32_bf16 v[96:99], v[40:43], v[52:55], v[96:99]
    buffer_load_dwordx4 v26, s[8:11], s46 offen offset:0 lds
    v_mfma_f32_16x16x32_bf16 v[104:107], v[40:43], v[56:59], v[104:107]
    s_add_u32 m0, s50, 24576
    s_add_u32 s42, s41, 0
    s_add_u32 s63, s40, 128
    v_mfma_f32_16x16x32_bf16 v[112:115], v[40:43], v[60:63], v[112:115]
    s_andn2_b32 s40, s63, 1024
    v_mfma_f32_16x16x32_bf16 v[120:123], v[40:43], v[64:67], v[120:123]
    s_add_u32 s43, s41, 31744
    buffer_load_dwordx4 v28, s[12:15], s42 offen offset:0 lds
    v_mfma_f32_16x16x32_bf16 v[128:131], v[40:43], v[68:71], v[128:131]
    s_waitcnt lgkmcnt(4)
    ds_read_b64_tr_b16 a[244:245], v24 offset:8
    ds_read_b64_tr_b16 a[246:247], v24 offset:1032
    v_mfma_f32_16x16x32_bf16 v[132:135], v[44:47], v[52:55], v[132:135]
    v_mfma_f32_16x16x32_bf16 v[140:143], v[44:47], v[56:59], v[140:143]
    v_mfma_f32_16x16x32_bf16 v[148:151], v[44:47], v[60:63], v[148:151]
    s_add_u32 s42, s41, 63488
    buffer_load_dwordx4 v28, s[12:15], s43 offen offset:1024 lds
    v_mfma_f32_16x16x32_bf16 v[156:159], v[44:47], v[64:67], v[156:159]
    v_mfma_f32_16x16x32_bf16 v[164:167], v[44:47], v[68:71], v[164:167]
    s_waitcnt lgkmcnt(4)
    ds_read_b64_tr_b16 a[248:249], v25 offset:0
    ds_read_b64_tr_b16 a[250:251], v25 offset:1024
    v_mfma_f32_16x16x32_bf16 v[136:139], v[48:51], v[52:55], v[136:139]
    v_mfma_f32_16x16x32_bf16 v[144:147], v[48:51], v[56:59], v[144:147]
    s_add_u32 s43, s41, 95232
    buffer_load_dwordx4 v28, s[12:15], s42 offen offset:2048 lds
    v_mfma_f32_16x16x32_bf16 v[152:155], v[48:51], v[60:63], v[152:155]
    s_add_u32 s41, s41, 262144
    v_mfma_f32_16x16x32_bf16 v[160:163], v[48:51], v[64:67], v[160:163]
    s_and_b32 s41, s41, 0x3fffff
    v_mfma_f32_16x16x32_bf16 v[168:171], v[48:51], v[68:71], v[168:171]
    s_waitcnt lgkmcnt(4)
    ds_read_b64_tr_b16 a[252:253], v25 offset:8
    ds_read_b64_tr_b16 a[254:255], v25 offset:1032
    v_mfma_f32_16x16x32_bf16 v[172:175], a[240:243], v[52:55], v[172:175]
    buffer_load_dwordx4 v28, s[12:15], s43 offen offset:3072 lds
    v_mfma_f32_16x16x32_bf16 v[180:183], a[240:243], v[56:59], v[180:183]
    v_mfma_f32_16x16x32_bf16 v[188:191], a[240:243], v[60:63], v[188:191]
    v_mfma_f32_16x16x32_bf16 v[196:199], a[240:243], v[64:67], v[196:199]
    v_mfma_f32_16x16x32_bf16 v[204:207], a[240:243], v[68:71], v[204:207]
    s_waitcnt lgkmcnt(4)
    v_mfma_f32_16x16x32_bf16 v[176:179], a[244:247], v[52:55], v[176:179]
    v_mfma_f32_16x16x32_bf16 v[184:187], a[244:247], v[56:59], v[184:187]
    s_waitcnt vmcnt(13) lgkmcnt(0)
    s_barrier
    v_mfma_f32_16x16x32_bf16 v[192:195], a[244:247], v[60:63], v[192:195]
    s_add_u32 m0, s50, 0
    ds_read_b64_tr_b16 v[36:37], v22 offset:8192
    ds_read_b64_tr_b16 v[38:39], v22 offset:9216
    v_mfma_f32_16x16x32_bf16 v[200:203], a[244:247], v[64:67], v[200:203]
    s_add_u32 s42, s41, 0
    s_cmp_eq_u32 s36, 2
    ds_read_b128 v[72:75], v21 offset:0
    ds_read_b128 v[76:79], v21 offset:2048
    v_mfma_f32_16x16x32_bf16 v[208:211], a[244:247], v[68:71], v[208:211]
    ds_read_b128 v[80:83], v21 offset:4096
    ds_read_b128 v[84:87], v21 offset:6144
    v_mfma_f32_16x16x32_bf16 v[212:215], a[248:251], v[52:55], v[212:215]
    s_cselect_b32 s10, 0, s10
    ds_read_b128 v[88:91], v21 offset:8192
    ds_read_b64_tr_b16 v[40:41], v22 offset:8200
    v_mfma_f32_16x16x32_bf16 v[220:223], a[248:251], v[56:59], v[220:223]
    s_cselect_b32 s14, 0, s14
    ds_read_b64_tr_b16 v[42:43], v22 offset:9224
    v_mfma_f32_16x16x32_bf16 v[228:231], a[248:251], v[60:63], v[228:231]
    v_mfma_f32_16x16x32_bf16 v[236:239], a[248:251], v[64:67], v[236:239]
    v_mfma_f32_16x16x32_bf16 v[244:247], a[248:251], v[68:71], v[244:247]
    ds_read_b64_tr_b16 v[44:45], v23 offset:8192
    ds_read_b64_tr_b16 v[46:47], v23 offset:9216
    v_mfma_f32_16x16x32_bf16 v[216:219], a[252:255], v[52:55], v[216:219]
    s_add_u32 s43, s41, 31744
    buffer_load_dwordx4 v28, s[12:15], s42 offen offset:0 lds
    v_mfma_f32_16x16x32_bf16 v[224:227], a[252:255], v[56:59], v[224:227]
    v_mfma_f32_16x16x32_bf16 v[232:235], a[252:255], v[60:63], v[232:235]
    v_mfma_f32_16x16x32_bf16 v[240:243], a[252:255], v[64:67], v[240:243]
    v_mfma_f32_16x16x32_bf16 v[248:251], a[252:255], v[68:71], v[248:251]
    s_waitcnt lgkmcnt(4)
    ds_read_b64_tr_b16 v[48:49], v23 offset:8200
    ds_read_b64_tr_b16 v[50:51], v23 offset:9224
    s_cmp_eq_u32 s100, 0
    s_cbranch_scc1 L_qb
    s_cmp_eq_u32 s36, 1
    s_cselect_b64 s[92:93], s[20:21], s[16:17]
    s_mov_b32 s94, 262144
    s_mov_b32 s95, 0x20000
    s_lshl_b32 s48, s36, 13
    s_add_u32 m0, s39, s48
    s_and_b32 s48, s48, 16384
    s_lshr_b32 s48, s48, 1
    buffer_load_dwordx4 v16, s[92:95], s48 offen offset:0 nt lds
    buffer_load_dwordx4 v17, s[92:95], s48 offen offset:1024 nt lds
    buffer_load_dwordx4 v18, s[92:95], s48 offen offset:2048 nt lds
    buffer_load_dwordx4 v19, s[92:95], s48 offen offset:3072 nt lds
    s_add_u32 m0, s50, 0
    buffer_store_dword v2, v1, s[4:7], 0 offen sc1
L_qb:
    s_add_u32 s36, s36, 1
    s_branch L_qloop
L_qdone:
    v_mfma_f32_16x16x32_bf16 v[92:95], v[36:39], v[72:75], v[92:95]
    v_mfma_f32_16x16x32_bf16 v[100:103], v[36:39], v[76:79], v[100:103]
    v_mfma_f32_16x16x32_bf16 v[108:111], v[36:39], v[80:83], v[108:111]
    v_mfma_f32_16x16x32_bf16 v[116:119], v[36:39], v[84:87], v[116:119]
    v_mfma_f32_16x16x32_bf16 v[124:127], v[36:39], v[88:91], v[124:127]
    s_waitcnt lgkmcnt(4)
    ds_read_b64_tr_b16 a[240:241], v24 offset:24576
    ds_read_b64_tr_b16 a[242:243], v24 offset:25600
    v_mfma_f32_16x16x32_bf16 v[96:99], v[40:43], v[72:75], v[96:99]
    v_mfma_f32_16x16x32_bf16 v[104:107], v[40:43], v[76:79], v[104:107]
    v_mfma_f32_16x16x32_bf16 v[112:115], v[40:43], v[80:83], v[112:115]
    ds_read_b128 v[36:39], v4 offset:0
    v_mfma_f32_16x16x32_bf16 v[120:123], v[40:43], v[84:87], v[120:123]
    v_mfma_f32_16x16x32_bf16 v[128:131], v[40:43], v[88:91], v[128:131]
    s_waitcnt lgkmcnt(5)
    ds_read_b64_tr_b16 a[244:245], v24 offset:24584
    ds_read_b64_tr_b16 a[246:247], v24 offset:25608
    v_mfma_f32_16x16x32_bf16 v[132:135], v[44:47], v[72:75], v[132:135]
    v_mfma_f32_16x16x32_bf16 v[140:143], v[44:47], v[76:79], v[140:143]
    v_mfma_f32_16x16x32_bf16 v[148:151], v[44:47], v[80:83], v[148:151]
    ds_read_b128 v[40:43], v5 offset:0
    v_mfma_f32_16x16x32_bf16 v[156:159], v[44:47], v[84:87], v[156:159]
    v_mfma_f32_16x16x32_bf16 v[164:167], v[44:47], v[88:91], v[164:167]
    s_waitcnt lgkmcnt(6)
    ds_read_b64_tr_b16 a[248:249], v25 offset:24576
    ds_read_b64_tr_b16 a[250:251], v25 offset:25600
    v_mul_f32 v92, s54, v92
    v_mul_f32 v93, s54, v93
    v_mul_f32 v94, s54, v94
    v_mul_f32 v95, s54, v95
    v_mfma_f32_16x16x32_bf16 v[136:139], v[48:51], v[72:75], v[136:139]
    v_mul_f32 v96, s54, v96
    v_mul_f32 v97, s54, v97
    v_mul_f32 v98, s54, v98
    v_mul_f32 v99, s54, v99
    v_mfma_f32_16x16x32_bf16 v[144:147], v[48:51], v[76:79], v[144:147]
    v_cvt_pk_bf16_f32 v92, v92, v93
    v_cvt_pk_bf16_f32 v93, v94, v95
    v_cvt_pk_bf16_f32 v94, v96, v97
    v_cvt_pk_bf16_f32 v95, v98, v99
    v_mfma_f32_16x16x32_bf16 v[152:155], v[48:51], v[80:83], v[152:155]
    ds_read_b128 v[44:47], v6 offset:0
    v_mul_f32 v100, s54, v100
    v_mul_f32 v101, s54, v101
    v_mul_f32 v102, s54, v102
    v_mul_f32 v103, s54, v103
    v_mfma_f32_16x16x32_bf16 v[160:163], v[48:51], v[84:87], v[160:163]
    v_mul_f32 v104, s54, v104
    v_mul_f32 v105, s54, v105
    v_mul_f32 v106, s54, v106
    v_mul_f32 v107, s54, v107
    v_mfma_f32_16x16x32_bf16 v[168:171], v[48:51], v[88:91], v[168:171]
    s_waitcnt lgkmcnt(7)
    ds_read_b64_tr_b16 a[252:253], v25 offset:24584
    v_cvt_pk_bf16_f32 v96, v100, v101
    v_cvt_pk_bf16_f32 v97, v102, v103
    v_cvt_pk_bf16_f32 v98, v104, v105
    v_cvt_pk_bf16_f32 v99, v106, v107
    v_mfma_f32_16x16x32_bf16 v[172:175], a[240:243], v[72:75], v[172:175]
    ds_read_b64_tr_b16 a[254:255], v25 offset:25608
    v_mul_f32 v108, s54, v108
    v_mul_f32 v109, s54, v109
    v_mul_f32 v110, s54, v110
    v_mul_f32 v111, s54, v111
    v_mfma_f32_16x16x32_bf16 v[180:183], a[240:243], v[76:79], v[180:183]
    v_mul_f32 v112, s54, v112
    v_mul_f32 v113, s54, v113
    v_mul_f32 v114, s54, v114
    v_mul_f32 v115, s54, v115
    v_mfma_f32_16x16x32_bf16 v[188:191], a[240:243], v[80:83], v[188:191]
    ds_read_b128 v[48:51], v7 offset:0
    v_cvt_pk_bf16_f32 v100, v108, v109
    v_cvt_pk_bf16_f32 v101, v110, v111
    v_cvt_pk_bf16_f32 v102, v112, v113
    v_cvt_pk_bf16_f32 v103, v114, v115
    v_mfma_f32_16x16x32_bf16 v[196:199], a[240:243], v[84:87], v[196:199]
    v_mul_f32 v116, s54, v116
    v_mul_f32 v117, s54, v117
    v_mul_f32 v118, s54, v118
    v_mul_f32 v119, s54, v119
    v_mfma_f32_16x16x32_bf16 v[204:207], a[240:243], v[88:91], v[204:207]
    s_waitcnt lgkmcnt(7)
    v_mul_f32 v120, s54, v120
    v_mul_f32 v121, s54, v121
    v_mul_f32 v122, s54, v122
    v_mul_f32 v123, s54, v123
    v_mfma_f32_16x16x32_bf16 v[176:179], a[244:247], v[72:75], v[176:179]
    v_cvt_pk_bf16_f32 v104, v116, v117
    v_cvt_pk_bf16_f32 v105, v118, v119
    v_cvt_pk_bf16_f32 v106, v120, v121
    v_cvt_pk_bf16_f32 v107, v122, v123
    v_mfma_f32_16x16x32_bf16 v[184:187], a[244:247], v[76:79], v[184:187]
    s_waitcnt vmcnt(0) lgkmcnt(0)
    s_barrier
    v_mfma_f32_16x16x32_bf16 v[192:195], a[244:247], v[80:83], v[192:195]
    s_cmp_eq_u32 s100, 0
    s_cbranch_scc1 L_nordy
    buffer_atomic_or v255, v3, s[84:87], 0 offen sc1
L_nordy:
    s_mov_b32 s100, 0
    v_mfma_f32_16x16x32_bf16 v[200:203], a[244:247], v[84:87], v[200:203]
    ds_read_b128 a[240:243], v4 offset:4096
    v_mul_f32 v124, s54, v124
    v_mul_f32 v125, s54, v125
    v_mul_f32 v126, s54, v126
    v_mul_f32 v127, s54, v127
    v_mfma_f32_16x16x32_bf16 v[208:211], a[244:247], v[88:91], v[208:211]
    s_lshl_b32 s63, s35, 17
    s_add_u32 s42, s63, 16384
    s_add_u32 m0, s39, 32768
    s_nop 0
    buffer_load_dwordx4 v16, s[16:19], s42 offen offset:0 nt lds
    v_mfma_f32_16x16x32_bf16 v[212:215], a[248:251], v[72:75], v[212:215]
    v_mul_f32 v128, s54, v128
    v_mul_f32 v129, s54, v129
    v_mul_f32 v130, s54, v130
    v_mul_f32 v131, s54, v131
    v_mfma_f32_16x16x32_bf16 v[220:223], a[248:251], v[76:79], v[220:223]
    v_cvt_pk_bf16_f32 v108, v124, v125
    v_cvt_pk_bf16_f32 v109, v126, v127
    v_cvt_pk_bf16_f32 v110, v128, v129
    v_cvt_pk_bf16_f32 v111, v130, v131
    v_mfma_f32_16x16x32_bf16 v[228:231], a[248:251], v[80:83], v[228:231]
    ds_read_b128 a[244:247], v5 offset:4096
    v_mfma_f32_16x16x32_bf16 v[236:239], a[248:251], v[84:87], v[236:239]
    buffer_load_dwordx4 v17, s[16:19], s42 offen offset:1024 nt lds
    v_mfma_f32_16x16x32_bf16 v[244:247], a[248:251], v[88:91], v[244:247]
    v_mul_f32 v132, s54, v132
    v_mul_f32 v133, s54, v133
    v_mul_f32 v134, s54, v134
    v_mul_f32 v135, s54, v135
    v_mul_f32 v136, s54, v136
    v_mul_f32 v137, s54, v137
    v_mfma_f32_16x16x32_bf16 v[216:219], a[252:255], v[72:75], v[216:219]
    v_mul_f32 v138, s54, v138
    v_mul_f32 v139, s54, v139
    v_cvt_pk_bf16_f32 v112, v132, v133
    v_cvt_pk_bf16_f32 v113, v134, v135
    v_cvt_pk_bf16_f32 v114, v136, v137
    v_cvt_pk_bf16_f32 v115, v138, v139
    v_mfma_f32_16x16x32_bf16 v[224:227], a[252:255], v[76:79], v[224:227]
    buffer_load_dwordx4 v18, s[16:19], s42 offen offset:2048 nt lds
    v_mfma_f32_16x16x32_bf16 v[232:235], a[252:255], v[80:83], v[232:235]
    ds_read_b128 a[248:251], v6 offset:4096
    v_mul_f32 v140, s54, v140
    v_mul_f32 v141, s54, v141
    v_mul_f32 v142, s54, v142
    v_mul_f32 v143, s54, v143
    v_mul_f32 v144, s54, v144
    v_mul_f32 v145, s54, v145
    v_mfma_f32_16x16x32_bf16 v[240:243], a[252:255], v[84:87], v[240:243]
    v_mul_f32 v146, s54, v146
    v_mul_f32 v147, s54, v147
    v_cvt_pk_bf16_f32 v116, v140, v141
    v_cvt_pk_bf16_f32 v117, v142, v143
    v_cvt_pk_bf16_f32 v118, v144, v145
    v_cvt_pk_bf16_f32 v119, v146, v147
    v_mfma_f32_16x16x32_bf16 v[248:251], a[252:255], v[88:91], v[248:251]
    buffer_load_dwordx4 v19, s[16:19], s42 offen offset:3072 nt lds
    v_mfma_f32_16x16x32_bf16 v[72:75], v[36:39], v[92:95], 0
    v_mul_f32 v148, s54, v148
    v_mul_f32 v149, s54, v149
    v_mul_f32 v150, s54, v150
    v_mul_f32 v151, s54, v151
    v_mul_f32 v152, s54, v152
    v_mul_f32 v153, s54, v153
    v_mfma_f32_16x16x32_bf16 v[76:79], v[36:39], v[96:99], 0
    v_mul_f32 v154, s54, v154
    v_mul_f32 v155, s54, v155
    v_cvt_pk_bf16_f32 v120, v148, v149
    v_cvt_pk_bf16_f32 v121, v150, v151
    v_cvt_pk_bf16_f32 v122, v152, v153
    v_cvt_pk_bf16_f32 v123, v154, v155
    v_mfma_f32_16x16x32_bf16 v[80:83], v[36:39], v[100:103], 0
    ds_read_b128 a[252:255], v7 offset:4096
    v_mul_f32 v156, s54, v156
    v_mul_f32 v157, s54, v157
    v_mul_f32 v158, s54, v158
    v_mul_f32 v159, s54, v159
    v_mul_f32 v160, s54, v160
    v_mul_f32 v161, s54, v161
    v_mfma_f32_16x16x32_bf16 v[84:87], v[36:39], v[104:107], 0
    s_lshl_b32 s63, s35, 17
    s_add_u32 s42, s63, 8192
    s_add_u32 m0, s39, 24576
    s_nop 0
    buffer_load_dwordx4 v16, s[20:23], s42 offen offset:0 nt lds
    v_mfma_f32_16x16x32_bf16 v[88:91], v[36:39], v[108:111], 0
    s_waitcnt lgkmcnt(3)
    v_mul_f32 v162, s54, v162
    v_mul_f32 v163, s54, v163
    v_cvt_pk_bf16_f32 v124, v156, v157
    v_cvt_pk_bf16_f32 v125, v158, v159
    v_cvt_pk_bf16_f32 v126, v160, v161
    v_cvt_pk_bf16_f32 v127, v162, v163
    v_mfma_f32_16x16x32_bf16 v[52:55], a[240:243], v[92:95], 0
    v_mul_f32 v164, s54, v164
    v_mul_f32 v165, s54, v165
    v_mul_f32 v166, s54, v166
    v_mul_f32 v167, s54, v167
    v_mul_f32 v168, s54, v168
    v_mul_f32 v169, s54, v169
    v_mfma_f32_16x16x32_bf16 v[56:59], a[240:243], v[96:99], 0
    buffer_load_dwordx4 v17, s[20:23], s42 offen offset:1024 nt lds
    v_mfma_f32_16x16x32_bf16 v[60:63], a[240:243], v[100:103], 0
    ds_read_b128 v[36:39], v4 offset:16384
    v_mul_f32 v170, s54, v170
    v_mul_f32 v171, s54, v171
    v_cvt_pk_bf16_f32 v128, v164, v165
    v_cvt_pk_bf16_f32 v129, v166, v167
    v_cvt_pk_bf16_f32 v130, v168, v169
    v_cvt_pk_bf16_f32 v131, v170, v171
    v_mfma_f32_16x16x32_bf16 v[64:67], a[240:243], v[104:107], 0
    v_mfma_f32_16x16x32_bf16 v[68:71], a[240:243], v[108:111], 0
    buffer_load_dwordx4 v18, s[20:23], s42 offen offset:2048 nt lds
    v_mfma_f32_16x16x32_bf16 v[72:75], v[40:43], v[112:115], v[72:75]
    v_mul_f32 v172, s54, v172
    v_mul_f32 v173, s54, v173
    v_mul_f32 v174, s54, v174
    v_mul_f32 v175, s54, v175
    v_mul_f32 v176, s54, v176
    v_mul_f32 v177, s54, v177
    v_mul_f32 v178, s54, v178
    v_mul_f32 v179, s54, v179
    v_cvt_pk_bf16_f32 v132, v172, v173
    v_mfma_f32_16x16x32_bf16 v[76:79], v[40:43], v[116:119], v[76:79]
    v_cvt_pk_bf16_f32 v133, v174, v175
    v_cvt_pk_bf16_f32 v134, v176, v177
    v_cvt_pk_bf16_f32 v135, v178, v179
    v_mul_f32 v180, s54, v180
    v_mul_f32 v181, s54, v181
    v_mul_f32 v182, s54, v182
    v_mul_f32 v183, s54, v183
    v_mul_f32 v184, s54, v184
    v_mul_f32 v185, s54, v185
    v_mfma_f32_16x16x32_bf16 v[80:83], v[40:43], v[120:123], v[80:83]
    v_mul_f32 v186, s54, v186
    v_mul_f32 v187, s54, v187
    v_cvt_pk_bf16_f32 v136, v180, v181
    v_cvt_pk_bf16_f32 v137, v182, v183
    v_cvt_pk_bf16_f32 v138, v184, v185
    v_cvt_pk_bf16_f32 v139, v186, v187
    v_mul_f32 v188, s54, v188
    v_mul_f32 v189, s54, v189
    v_mul_f32 v190, s54, v190
    v_mfma_f32_16x16x32_bf16 v[84:87], v[40:43], v[124:127], v[84:87]
    buffer_load_dwordx4 v19, s[20:23], s42 offen offset:3072 nt lds
    v_mfma_f32_16x16x32_bf16 v[88:91], v[40:43], v[128:131], v[88:91]
    s_waitcnt lgkmcnt(3)
    v_mul_f32 v191, s54, v191
    v_mul_f32 v192, s54, v192
    v_mul_f32 v193, s54, v193
    v_mul_f32 v194, s54, v194
    v_mul_f32 v195, s54, v195
    v_cvt_pk_bf16_f32 v140, v188, v189
    v_cvt_pk_bf16_f32 v141, v190, v191
    v_cvt_pk_bf16_f32 v142, v192, v193
    v_cvt_pk_bf16_f32 v143, v194, v195
    v_mfma_f32_16x16x32_bf16 v[52:55], a[244:247], v[112:115], v[52:55]
    v_mul_f32 v196, s54, v196
    v_mul_f32 v197, s54, v197
    v_mul_f32 v198, s54, v198
    v_mul_f32 v199, s54, v199
    v_mul_f32 v200, s54, v200
    v_mul_f32 v201, s54, v201
    v_mul_f32 v202, s54, v202
    v_mul_f32 v203, s54, v203
    v_cvt_pk_bf16_f32 v144, v196, v197
    v_mfma_f32_16x16x32_bf16 v[56:59], a[244:247], v[116:119], v[56:59]
    s_lshl_b32 s63, s35, 17
    s_add_u32 s42, s63, 24576
    s_add_u32 m0, s39, 49152
    s_nop 0
    buffer_load_dwordx4 v16, s[16:19], s42 offen offset:0 nt lds
    v_mfma_f32_16x16x32_bf16 v[60:63], a[244:247], v[120:123], v[60:63]
    ds_read_b128 v[40:43], v5 offset:16384
    v_cvt_pk_bf16_f32 v145, v198, v199
    v_cvt_pk_bf16_f32 v146, v200, v201
    v_cvt_pk_bf16_f32 v147, v202, v203
    v_mul_f32 v204, s54, v204
    v_mul_f32 v205, s54, v205
    v_mul_f32 v206, s54, v206
    v_mul_f32 v207, s54, v207
    v_mul_f32 v208, s54, v208
    v_mul_f32 v209, s54, v209
    v_mfma_f32_16x16x32_bf16 v[64:67], a[244:247], v[124:127], v[64:67]
    v_mul_f32 v210, s54, v210
    v_mul_f32 v211, s54, v211
    v_cvt_pk_bf16_f32 v148, v204, v205
    v_cvt_pk_bf16_f32 v149, v206, v207
    v_cvt_pk_bf16_f32 v150, v208, v209
    v_cvt_pk_bf16_f32 v151, v210, v211
    v_mfma_f32_16x16x32_bf16 v[68:71], a[244:247], v[128:131], v[68:71]
    v_mul_f32 v212, s54, v212
    v_mul_f32 v213, s54, v213
    v_mul_f32 v214, s54, v214
    v_mul_f32 v215, s54, v215
    v_mul_f32 v216, s54, v216
    v_mul_f32 v217, s54, v217
    v_mul_f32 v218, s54, v218
    v_mul_f32 v219, s54, v219
    v_cvt_pk_bf16_f32 v152, v212, v213
    v_mfma_f32_16x16x32_bf16 v[72:75], v[44:47], v[132:135], v[72:75]
    buffer_load_dwordx4 v17, s[16:19], s42 offen offset:1024 nt lds
    v_mfma_f32_16x16x32_bf16 v[76:79], v[44:47], v[136:139], v[76:79]
    v_cvt_pk_bf16_f32 v153, v214, v215
    v_cvt_pk_bf16_f32 v154, v216, v217
    v_cvt_pk_bf16_f32 v155, v218, v219
    v_mul_f32 v220, s54, v220
    v_mul_f32 v221, s54, v221
    v_mul_f32 v222, s54, v222
    v_mul_f32 v223, s54, v223
    v_mul_f32 v224, s54, v224
    v_mul_f32 v225, s54, v225
    v_mfma_f32_16x16x32_bf16 v[80:83], v[44:47], v[140:143], v[80:83]
    v_mul_f32 v226, s54, v226
    v_mul_f32 v227, s54, v227
    v_cvt_pk_bf16_f32 v156, v220, v221
    v_cvt_pk_bf16_f32 v157, v222, v223
    v_cvt_pk_bf16_f32 v158, v224, v225
    v_cvt_pk_bf16_f32 v159, v226, v227
    v_mul_f32 v228, s54, v228
    v_mul_f32 v229, s54, v229
    v_mul_f32 v230, s54, v230
    v_mfma_f32_16x16x32_bf16 v[84:87], v[44:47], v[144:147], v[84:87]
    v_mul_f32 v231, s54, v231
    v_mul_f32 v232, s54, v232
    v_mul_f32 v233, s54, v233
    v_mul_f32 v234, s54, v234
    v_mul_f32 v235, s54, v235
    v_cvt_pk_bf16_f32 v160, v228, v229
    v_cvt_pk_bf16_f32 v161, v230, v231
    v_cvt_pk_bf16_f32 v162, v232, v233
    v_cvt_pk_bf16_f32 v163, v234, v235
    v_mfma_f32_16x16x32_bf16 v[88:91], v[44:47], v[148:151], v[88:91]
    s_waitcnt lgkmcnt(3)
    buffer_load_dwordx4 v18, s[16:19], s42 offen offset:2048 nt lds
    v_mfma_f32_16x16x32_bf16 v[52:55], a[248:251], v[132:135], v[52:55]
    v_mul_f32 v236, s54, v236
    v_mul_f32 v237, s54, v237
    v_mul_f32 v238, s54, v238
    v_mul_f32 v239, s54, v239
    v_mul_f32 v240, s54, v240
    v_mul_f32 v241, s54, v241
    v_mul_f32 v242, s54, v242
    v_mul_f32 v243, s54, v243
    v_cvt_pk_bf16_f32 v164, v236, v237
    v_mfma_f32_16x16x32_bf16 v[56:59], a[248:251], v[136:139], v[56:59]
    v_cvt_pk_bf16_f32 v165, v238, v239
    v_cvt_pk_bf16_f32 v166, v240, v241
    v_cvt_pk_bf16_f32 v167, v242, v243
    v_mul_f32 v244, s54, v244
    v_mul_f32 v245, s54, v245
    v_mul_f32 v246, s54, v246
    v_mul_f32 v247, s54, v247
    v_mul_f32 v248, s54, v248
    v_mul_f32 v249, s54, v249
    v_mfma_f32_16x16x32_bf16 v[60:63], a[248:251], v[140:143], v[60:63]
    ds_read_b128 v[44:47], v6 offset:16384
    v_mul_f32 v250, s54, v250
    v_mul_f32 v251, s54, v251
    v_cvt_pk_bf16_f32 v168, v244, v245
    v_cvt_pk_bf16_f32 v169, v246, v247
    v_cvt_pk_bf16_f32 v170, v248, v249
    v_cvt_pk_bf16_f32 v171, v250, v251
    v_mfma_f32_16x16x32_bf16 v[64:67], a[248:251], v[144:147], v[64:67]
    buffer_load_dwordx4 v19, s[16:19], s42 offen offset:3072 nt lds
    v_mfma_f32_16x16x32_bf16 v[68:71], a[248:251], v[148:151], v[68:71]
    v_mfma_f32_16x16x32_bf16 v[72:75], v[48:51], v[152:155], v[72:75]
    v_mfma_f32_16x16x32_bf16 v[76:79], v[48:51], v[156:159], v[76:79]
    s_lshl_b32 s63, s35, 17
    s_add_u32 s37, s63, 32768
    v_mfma_f32_16x16x32_bf16 v[80:83], v[48:51], v[160:163], v[80:83]
    s_add_u32 s38, s63, 24576
    s_mov_b32 s36, 0
    v_mfma_f32_16x16x32_bf16 v[84:87], v[48:51], v[164:167], v[84:87]
    v_mfma_f32_16x16x32_bf16 v[88:91], v[48:51], v[168:171], v[88:91]
    s_waitcnt lgkmcnt(3)
    v_mfma_f32_16x16x32_bf16 v[52:55], a[252:255], v[152:155], v[52:55]
    v_mfma_f32_16x16x32_bf16 v[56:59], a[252:255], v[156:159], v[56:59]
    v_mfma_f32_16x16x32_bf16 v[60:63], a[252:255], v[160:163], v[60:63]
    ds_read_b128 v[48:51], v7 offset:16384
    v_mfma_f32_16x16x32_bf16 v[64:67], a[252:255], v[164:167], v[64:67]
    v_mfma_f32_16x16x32_bf16 v[68:71], a[252:255], v[168:171], v[68:71]
    s_waitcnt lgkmcnt(3)
    v_mfma_f32_16x16x32_bf16 v[172:175], v[36:39], v[92:95], 0
    ds_read_b128 a[240:243], v4 offset:20480
    v_mfma_f32_16x16x32_bf16 v[176:179], v[36:39], v[96:99], 0
    s_waitcnt lgkmcnt(0)
    s_barrier
    v_mfma_f32_16x16x32_bf16 v[180:183], v[36:39], v[100:103], 0
    s_lshl_b32 s63, s35, 17
    s_add_u32 s42, s63, 16384
    s_add_u32 m0, s39, 40960
    s_nop 0
    buffer_load_dwordx4 v16, s[20:23], s42 offen offset:0 nt lds
    v_mfma_f32_16x16x32_bf16 v[184:187], v[36:39], v[104:107], 0
    v_exp_f32 v72, v72
    v_exp_f32 v73, v73
    v_exp_f32 v74, v74
    v_mfma_f32_16x16x32_bf16 v[188:191], v[36:39], v[108:111], 0
    v_exp_f32 v75, v75
    v_cvt_pk_bf16_f32 v212, v72, v73
    v_cvt_pk_bf16_f32 v213, v74, v75
    v_exp_f32 v76, v76
    v_mfma_f32_16x16x32_bf16 v[172:175], v[40:43], v[112:115], v[172:175]
    v_exp_f32 v77, v77
    v_exp_f32 v78, v78
    v_exp_f32 v79, v79
    v_mfma_f32_16x16x32_bf16 v[176:179], v[40:43], v[116:119], v[176:179]
    ds_read_b128 a[244:247], v5 offset:20480
    v_cvt_pk_bf16_f32 v216, v76, v77
    v_cvt_pk_bf16_f32 v217, v78, v79
    v_exp_f32 v80, v80
    v_mfma_f32_16x16x32_bf16 v[180:183], v[40:43], v[120:123], v[180:183]
    buffer_load_dwordx4 v17, s[20:23], s42 offen offset:1024 nt lds
    v_mfma_f32_16x16x32_bf16 v[184:187], v[40:43], v[124:127], v[184:187]
    v_exp_f32 v81, v81
    v_exp_f32 v82, v82
    v_exp_f32 v83, v83
    v_mfma_f32_16x16x32_bf16 v[188:191], v[40:43], v[128:131], v[188:191]
    v_cvt_pk_bf16_f32 v220, v80, v81
    v_cvt_pk_bf16_f32 v221, v82, v83
    v_exp_f32 v84, v84
    v_exp_f32 v85, v85
    v_mfma_f32_16x16x32_bf16 v[172:175], v[44:47], v[132:135], v[172:175]
    ds_read_b128 a[248:251], v6 offset:20480
    v_exp_f32 v86, v86
    v_exp_f32 v87, v87
    v_mfma_f32_16x16x32_bf16 v[176:179], v[44:47], v[136:139], v[176:179]
    v_cvt_pk_bf16_f32 v224, v84, v85
    v_cvt_pk_bf16_f32 v225, v86, v87
    v_exp_f32 v88, v88
    v_exp_f32 v89, v89
    v_mfma_f32_16x16x32_bf16 v[180:183], v[44:47], v[140:143], v[180:183]
    buffer_load_dwordx4 v18, s[20:23], s42 offen offset:2048 nt lds
    v_mfma_f32_16x16x32_bf16 v[184:187], v[44:47], v[144:147], v[184:187]
    v_exp_f32 v90, v90
    v_exp_f32 v91, v91
    v_mfma_f32_16x16x32_bf16 v[188:191], v[44:47], v[148:151], v[188:191]
    v_cvt_pk_bf16_f32 v228, v88, v89
    v_cvt_pk_bf16_f32 v229, v90, v91
    v_exp_f32 v52, v52
    v_mfma_f32_16x16x32_bf16 v[172:175], v[48:51], v[152:155], v[172:175]
    ds_read_b128 a[252:255], v7 offset:20480
    v_exp_f32 v53, v53
    v_mfma_f32_16x16x32_bf16 v[176:179], v[48:51], v[156:159], v[176:179]
    v_exp_f32 v54, v54
    v_exp_f32 v55, v55
    v_mfma_f32_16x16x32_bf16 v[180:183], v[48:51], v[160:163], v[180:183]
    buffer_load_dwordx4 v19, s[20:23], s42 offen offset:3072 nt lds
    v_mfma_f32_16x16x32_bf16 v[184:187], v[48:51], v[164:167], v[184:187]
    v_cvt_pk_bf16_f32 v214, v52, v53
    v_cvt_pk_bf16_f32 v215, v54, v55
    v_exp_f32 v56, v56
    v_mfma_f32_16x16x32_bf16 v[188:191], v[48:51], v[168:171], v[188:191]
    v_exp_f32 v57, v57
    v_exp_f32 v58, v58
    v_mfma_f32_16x16x32_bf16 v[192:195], a[240:243], v[92:95], 0
    ds_read_b64_tr_b16 v[36:37], v8 offset:0
    ds_read_b64_tr_b16 v[38:39], v8 offset:4096
    v_exp_f32 v59, v59
    v_mfma_f32_16x16x32_bf16 v[196:199], a[240:243], v[96:99], 0
    v_cvt_pk_bf16_f32 v218, v56, v57
    v_cvt_pk_bf16_f32 v219, v58, v59
    v_exp_f32 v60, v60
    v_mfma_f32_16x16x32_bf16 v[200:203], a[240:243], v[100:103], 0
    s_add_u32 m0, s39, 0
    s_nop 0
    buffer_load_dwordx4 v16, s[16:19], s37 offen offset:0 nt lds
    v_exp_f32 v172, v172
    v_mfma_f32_16x16x32_bf16 v[204:207], a[240:243], v[104:107], 0
    v_exp_f32 v61, v61
    v_exp_f32 v62, v62
    v_mfma_f32_16x16x32_bf16 v[208:211], a[240:243], v[108:111], 0
    s_waitcnt lgkmcnt(4)
    ds_read_b64_tr_b16 v[40:41], v9 offset:0
    ds_read_b64_tr_b16 v[42:43], v9 offset:4096
    v_exp_f32 v63, v63
    v_mfma_f32_16x16x32_bf16 v[192:195], a[244:247], v[112:115], v[192:195]
    v_exp_f32 v173, v173
    v_cvt_pk_bf16_f32 v222, v60, v61
    v_cvt_pk_bf16_f32 v223, v62, v63
    v_mfma_f32_16x16x32_bf16 v[196:199], a[244:247], v[116:119], v[196:199]
    v_exp_f32 v174, v174
    v_exp_f32 v64, v64
    v_mfma_f32_16x16x32_bf16 v[200:203], a[244:247], v[120:123], v[200:203]
    v_exp_f32 v175, v175
    v_exp_f32 v65, v65
    v_mfma_f32_16x16x32_bf16 v[204:207], a[244:247], v[124:127], v[204:207]
    ds_read_b64_tr_b16 v[44:45], v10 offset:0
    ds_read_b64_tr_b16 v[46:47], v10 offset:4096
    v_exp_f32 v66, v66
    v_mfma_f32_16x16x32_bf16 v[208:211], a[244:247], v[128:131], v[208:211]
    s_waitcnt lgkmcnt(7)
    buffer_load_dwordx4 v17, s[16:19], s37 offen offset:1024 nt lds
    v_mfma_f32_16x16x32_bf16 v[192:195], a[248:251], v[132:135], v[192:195]
    v_cvt_pk_bf16_f32 v232, v172, v173
    v_cvt_pk_bf16_f32 v233, v174, v175
    v_exp_f32 v67, v67
    v_mfma_f32_16x16x32_bf16 v[196:199], a[248:251], v[136:139], v[196:199]
    v_exp_f32 v176, v176
    v_cvt_pk_bf16_f32 v226, v64, v65
    v_cvt_pk_bf16_f32 v227, v66, v67
    v_mfma_f32_16x16x32_bf16 v[200:203], a[248:251], v[140:143], v[200:203]
    ds_read_b64_tr_b16 v[48:49], v11 offset:0
    ds_read_b64_tr_b16 v[50:51], v11 offset:4096
    v_exp_f32 v68, v68
    v_mfma_f32_16x16x32_bf16 v[204:207], a[248:251], v[144:147], v[204:207]
    v_exp_f32 v177, v177
    v_exp_f32 v69, v69
    v_mfma_f32_16x16x32_bf16 v[208:211], a[248:251], v[148:151], v[208:211]
    s_waitcnt lgkmcnt(8)
    buffer_load_dwordx4 v18, s[16:19], s37 offen offset:2048 nt lds
    v_exp_f32 v178, v178
    v_mfma_f32_16x16x32_bf16 v[192:195], a[252:255], v[152:155], v[192:195]
    v_exp_f32 v179, v179
    v_exp_f32 v70, v70
    v_mfma_f32_16x16x32_bf16 v[196:199], a[252:255], v[156:159], v[196:199]
    ds_read_b64_tr_b16 a[240:241], v12 offset:0
    ds_read_b64_tr_b16 a[242:243], v12 offset:4096
    v_exp_f32 v71, v71
    v_mfma_f32_16x16x32_bf16 v[200:203], a[252:255], v[160:163], v[200:203]
    v_cvt_pk_bf16_f32 v236, v176, v177
    v_cvt_pk_bf16_f32 v237, v178, v179
    v_cvt_pk_bf16_f32 v230, v68, v69
    v_cvt_pk_bf16_f32 v231, v70, v71
    v_mfma_f32_16x16x32_bf16 v[204:207], a[252:255], v[164:167], v[204:207]
    v_exp_f32 v180, v180
    v_mfma_f32_16x16x32_bf16 v[208:211], a[252:255], v[168:171], v[208:211]
    buffer_load_dwordx4 v19, s[16:19], s37 offen offset:3072 nt lds
    v_exp_f32 v181, v181
    v_mfma_f32_16x16x32_bf16 v[52:55], v[32:35], v[212:215], 0
    ds_read_b64_tr_b16 a[244:245], v13 offset:0
    ds_read_b64_tr_b16 a[246:247], v13 offset:4096
    v_mfma_f32_16x16x32_bf16 v[56:59], v[32:35], v[216:219], 0
    v_exp_f32 v182, v182
    v_mfma_f32_16x16x32_bf16 v[60:63], v[32:35], v[220:223], 0
    v_exp_f32 v183, v183
    v_mfma_f32_16x16x32_bf16 v[64:67], v[32:35], v[224:227], 0
    v_cvt_pk_bf16_f32 v240, v180, v181
    v_cvt_pk_bf16_f32 v241, v182, v183
    v_mfma_f32_16x16x32_bf16 v[68:71], v[32:35], v[228:231], 0
    s_waitcnt lgkmcnt(10)
    ds_read_b64_tr_b16 a[248:249], v14 offset:0
    ds_read_b64_tr_b16 a[250:251], v14 offset:4096
    v_mfma_f32_16x16x32_bf16 a[0:3], v[36:39], v[212:215], 0
    s_add_u32 m0, s39, 57344
    s_add_u32 s37, s37, 8192
    buffer_load_dwordx4 v16, s[20:23], s38 offen offset:0 nt lds
    v_exp_f32 v184, v184
    v_mfma_f32_16x16x32_bf16 a[4:7], v[36:39], v[216:219], 0
    v_exp_f32 v185, v185
    v_mov_b32 v72, 0
    v_mov_b32 v73, 0
    v_mfma_f32_16x16x32_bf16 a[8:11], v[36:39], v[220:223], 0
    v_exp_f32 v186, v186
    v_mfma_f32_16x16x32_bf16 a[12:15], v[36:39], v[224:227], 0
    ds_read_b64_tr_b16 a[252:253], v15 offset:0
    ds_read_b64_tr_b16 a[254:255], v15 offset:4096
    v_mfma_f32_16x16x32_bf16 a[16:19], v[36:39], v[228:231], 0
    s_waitcnt lgkmcnt(12)
    v_exp_f32 v187, v187
    v_mov_b32 v74, 0
    v_mov_b32 v75, 0
    v_mfma_f32_16x16x32_bf16 a[20:23], v[40:43], v[212:215], 0
    v_cvt_pk_bf16_f32 v244, v184, v185
    v_cvt_pk_bf16_f32 v245, v186, v187
    v_mfma_f32_16x16x32_bf16 a[24:27], v[40:43], v[216:219], 0
    buffer_load_dwordx4 v17, s[20:23], s38 offen offset:1024 nt lds
    v_exp_f32 v188, v188
    v_mfma_f32_16x16x32_bf16 a[28:31], v[40:43], v[220:223], 0
    v_exp_f32 v189, v189
    v_mfma_f32_16x16x32_bf16 a[32:35], v[40:43], v[224:227], 0
    v_exp_f32 v190, v190
    v_mov_b32 v76, 0
    v_mov_b32 v77, 0
    v_mfma_f32_16x16x32_bf16 a[36:39], v[40:43], v[228:231], 0
    s_waitcnt lgkmcnt(10)
    v_exp_f32 v191, v191
    v_mfma_f32_16x16x32_bf16 a[40:43], v[44:47], v[212:215], 0
    buffer_load_dwordx4 v18, s[20:23], s38 offen offset:2048 nt lds
    v_cvt_pk_bf16_f32 v248, v188, v189
    v_cvt_pk_bf16_f32 v249, v190, v191
    v_mfma_f32_16x16x32_bf16 a[44:47], v[44:47], v[216:219], 0
    v_exp_f32 v192, v192
    v_mfma_f32_16x16x32_bf16 a[48:51], v[44:47], v[220:223], 0
    v_exp_f32 v193, v193
    v_mov_b32 v78, 0
    v_mov_b32 v79, 0
    v_mfma_f32_16x16x32_bf16 a[52:55], v[44:47], v[224:227], 0
    v_exp_f32 v194, v194
    v_mfma_f32_16x16x32_bf16 a[56:59], v[44:47], v[228:231], 0
    s_waitcnt lgkmcnt(8)
    buffer_load_dwordx4 v19, s[20:23], s38 offen offset:3072 nt lds
    v_exp_f32 v195, v195
    v_mfma_f32_16x16x32_bf16 a[60:63], v[48:51], v[212:215], 0
    v_cvt_pk_bf16_f32 v234, v192, v193
    v_cvt_pk_bf16_f32 v235, v194, v195
    v_mfma_f32_16x16x32_bf16 a[64:67], v[48:51], v[216:219], 0
    v_exp_f32 v196, v196
    v_mov_b32 v80, 0
    v_mov_b32 v81, 0
    v_mfma_f32_16x16x32_bf16 a[68:71], v[48:51], v[220:223], 0
    v_exp_f32 v197, v197
    v_mfma_f32_16x16x32_bf16 a[72:75], v[48:51], v[224:227], 0
    s_add_u32 s38, s38, 8192
    v_exp_f32 v198, v198
    v_mfma_f32_16x16x32_bf16 a[76:79], v[48:51], v[228:231], 0
    s_waitcnt lgkmcnt(6)
    v_exp_f32 v199, v199
    v_mfma_f32_16x16x32_bf16 a[80:83], a[240:243], v[212:215], 0
    v_cvt_pk_bf16_f32 v238, v196, v197
    v_cvt_pk_bf16_f32 v239, v198, v199
    v_mov_b32 v82, 0
    v_mov_b32 v83, 0
    v_mfma_f32_16x16x32_bf16 a[84:87], a[240:243], v[216:219], 0
    v_exp_f32 v200, v200
    v_mfma_f32_16x16x32_bf16 a[88:91], a[240:243], v[220:223], 0
    v_exp_f32 v201, v201
    v_mfma_f32_16x16x32_bf16 a[92:95], a[240:243], v[224:227], 0
    v_exp_f32 v202, v202
    v_mov_b32 v84, 0
    v_mov_b32 v85, 0
    v_mfma_f32_16x16x32_bf16 a[96:99], a[240:243], v[228:231], 0
    s_waitcnt lgkmcnt(4)
    v_exp_f32 v203, v203
    v_mfma_f32_16x16x32_bf16 a[100:103], a[244:247], v[212:215], 0
    s_waitcnt vmcnt(16) lgkmcnt(0)
    s_barrier
    v_mfma_f32_16x16x32_bf16 a[104:107], a[244:247], v[216:219], 0
    s_add_u32 m0, s39, 16384
    ds_read_b128 v[36:39], v4 offset:32768
    ds_read_b128 v[40:43], v5 offset:32768
    v_mfma_f32_16x16x32_bf16 a[108:111], a[244:247], v[220:223], 0
    buffer_load_dwordx4 v16, s[16:19], s37 offen offset:0 nt lds
    v_mov_b32 v86, 0
    v_mov_b32 v87, 0
    v_mfma_f32_16x16x32_bf16 a[112:115], a[244:247], v[224:227], 0
    v_cvt_pk_bf16_f32 v242, v200, v201
    v_cvt_pk_bf16_f32 v243, v202, v203
    v_mfma_f32_16x16x32_bf16 a[116:119], a[244:247], v[228:231], 0
    v_exp_f32 v204, v204
    v_mfma_f32_16x16x32_bf16 a[120:123], a[248:251], v[212:215], 0
    ds_read_b128 v[44:47], v6 offset:32768
    v_mov_b32 v88, 0
    v_mov_b32 v89, 0
    v_mfma_f32_16x16x32_bf16 a[124:127], a[248:251], v[216:219], 0
    v_exp_f32 v205, v205
    v_mfma_f32_16x16x32_bf16 a[128:131], a[248:251], v[220:223], 0
    v_exp_f32 v206, v206
    v_mfma_f32_16x16x32_bf16 a[132:135], a[248:251], v[224:227], 0
    buffer_load_dwordx4 v17, s[16:19], s37 offen offset:1024 nt lds
    v_mov_b32 v90, 0
    v_mov_b32 v91, 0
    v_mfma_f32_16x16x32_bf16 a[136:139], a[248:251], v[228:231], 0
    v_exp_f32 v207, v207
    v_mfma_f32_16x16x32_bf16 a[140:143], a[252:255], v[212:215], 0
    ds_read_b128 v[48:51], v7 offset:32768
    v_cvt_pk_bf16_f32 v246, v204, v205
    v_mfma_f32_16x16x32_bf16 a[144:147], a[252:255], v[216:219], 0
    v_cvt_pk_bf16_f32 v247, v206, v207
    v_mfma_f32_16x16x32_bf16 a[148:151], a[252:255], v[220:223], 0
    v_exp_f32 v208, v208
    v_mfma_f32_16x16x32_bf16 a[152:155], a[252:255], v[224:227], 0
    v_exp_f32 v209, v209
    v_mfma_f32_16x16x32_bf16 a[156:159], a[252:255], v[228:231], 0
    s_waitcnt lgkmcnt(3)
    buffer_load_dwordx4 v18, s[16:19], s37 offen offset:2048 nt lds
.p2align 3
L_aloop:
    v_mfma_f32_16x16x32_bf16 v[172:175], v[36:39], v[92:95], v[72:75]
    ds_read_b128 a[240:243], v4 offset:36864
    v_cvt_pk_bf16_f32 v250, v208, v209
    v_mfma_f32_16x16x32_bf16 v[176:179], v[36:39], v[96:99], v[76:79]
    v_exp_f32 v210, v210
    v_mfma_f32_16x16x32_bf16 v[180:183], v[36:39], v[100:103], v[80:83]
    v_exp_f32 v211, v211
    v_mfma_f32_16x16x32_bf16 v[184:187], v[36:39], v[104:107], v[84:87]
    v_cvt_pk_bf16_f32 v251, v210, v211
    v_mfma_f32_16x16x32_bf16 v[188:191], v[36:39], v[108:111], v[88:91]
    s_waitcnt lgkmcnt(3)
    v_mfma_f32_16x16x32_bf16 v[172:175], v[40:43], v[112:115], v[172:175]
    buffer_load_dwordx4 v19, s[16:19], s37 offen offset:3072 nt lds
    v_mfma_f32_16x16x32_bf16 v[176:179], v[40:43], v[116:119], v[176:179]
    s_add_u32 m0, s39, 8192
    s_add_u32 s37, s37, 8192
    ds_read_b128 a[244:247], v5 offset:36864
    v_mfma_f32_16x16x32_bf16 v[180:183], v[40:43], v[120:123], v[180:183]
    v_mfma_f32_16x16x32_bf16 v[184:187], v[40:43], v[124:127], v[184:187]
    v_mfma_f32_16x16x32_bf16 v[188:191], v[40:43], v[128:131], v[188:191]
    s_waitcnt lgkmcnt(3)
    v_mfma_f32_16x16x32_bf16 v[172:175], v[44:47], v[132:135], v[172:175]
    ds_read_b128 a[248:251], v6 offset:36864
    v_mfma_f32_16x16x32_bf16 v[176:179], v[44:47], v[136:139], v[176:179]
    buffer_load_dwordx4 v16, s[20:23], s38 offen offset:0 nt lds
    v_mfma_f32_16x16x32_bf16 v[180:183], v[44:47], v[140:143], v[180:183]
    v_mfma_f32_16x16x32_bf16 v[184:187], v[44:47], v[144:147], v[184:187]
    v_mfma_f32_16x16x32_bf16 v[188:191], v[44:47], v[148:151], v[188:191]
    s_waitcnt lgkmcnt(3)
    v_mfma_f32_16x16x32_bf16 v[172:175], v[48:51], v[152:155], v[172:175]
    ds_read_b128 a[252:255], v7 offset:36864
    v_mfma_f32_16x16x32_bf16 v[176:179], v[48:51], v[156:159], v[176:179]
    v_mfma_f32_16x16x32_bf16 v[180:183], v[48:51], v[160:163], v[180:183]
    buffer_load_dwordx4 v17, s[20:23], s38 offen offset:1024 nt lds
    v_mfma_f32_16x16x32_bf16 v[184:187], v[48:51], v[164:167], v[184:187]
    v_mfma_f32_16x16x32_bf16 v[188:191], v[48:51], v[168:171], v[188:191]
    s_waitcnt lgkmcnt(3)
    v_mfma_f32_16x16x32_bf16 v[192:195], a[240:243], v[92:95], v[72:75]
    ds_read_b64_tr_b16 v[36:37], v8 offset:16384
    ds_read_b64_tr_b16 v[38:39], v8 offset:20480
    v_mfma_f32_16x16x32_bf16 v[196:199], a[240:243], v[96:99], v[76:79]
    v_mfma_f32_16x16x32_bf16 v[200:203], a[240:243], v[100:103], v[80:83]
    v_exp_f32 v172, v172
    v_mfma_f32_16x16x32_bf16 v[204:207], a[240:243], v[104:107], v[84:87]
    buffer_load_dwordx4 v18, s[20:23], s38 offen offset:2048 nt lds
    v_mfma_f32_16x16x32_bf16 v[208:211], a[240:243], v[108:111], v[88:91]
    s_waitcnt lgkmcnt(4)
    ds_read_b64_tr_b16 v[40:41], v9 offset:16384
    ds_read_b64_tr_b16 v[42:43], v9 offset:20480
    v_mfma_f32_16x16x32_bf16 v[192:195], a[244:247], v[112:115], v[192:195]
    v_exp_f32 v173, v173
    v_mfma_f32_16x16x32_bf16 v[196:199], a[244:247], v[116:119], v[196:199]
    v_exp_f32 v174, v174
    v_mfma_f32_16x16x32_bf16 v[200:203], a[244:247], v[120:123], v[200:203]
    v_exp_f32 v175, v175
    v_mfma_f32_16x16x32_bf16 v[204:207], a[244:247], v[124:127], v[204:207]
    ds_read_b64_tr_b16 v[44:45], v10 offset:16384
    ds_read_b64_tr_b16 v[46:47], v10 offset:20480
    v_mfma_f32_16x16x32_bf16 v[208:211], a[244:247], v[128:131], v[208:211]
    s_waitcnt lgkmcnt(7)
    buffer_load_dwordx4 v19, s[20:23], s38 offen offset:3072 nt lds
    v_mfma_f32_16x16x32_bf16 v[192:195], a[248:251], v[132:135], v[192:195]
    s_add_u32 s38, s38, 8192
    v_cvt_pk_bf16_f32 v212, v172, v173
    v_cvt_pk_bf16_f32 v213, v174, v175
    v_mfma_f32_16x16x32_bf16 v[196:199], a[248:251], v[136:139], v[196:199]
    v_exp_f32 v176, v176
    v_mfma_f32_16x16x32_bf16 v[200:203], a[248:251], v[140:143], v[200:203]
    ds_read_b64_tr_b16 v[48:49], v11 offset:16384
    ds_read_b64_tr_b16 v[50:51], v11 offset:20480
    v_mfma_f32_16x16x32_bf16 v[204:207], a[248:251], v[144:147], v[204:207]
    v_exp_f32 v177, v177
    v_mfma_f32_16x16x32_bf16 v[208:211], a[248:251], v[148:151], v[208:211]
    s_waitcnt lgkmcnt(8)
    v_exp_f32 v178, v178
    v_mfma_f32_16x16x32_bf16 v[192:195], a[252:255], v[152:155], v[192:195]
    v_exp_f32 v179, v179
    v_mfma_f32_16x16x32_bf16 v[196:199], a[252:255], v[156:159], v[196:199]
    ds_read_b64_tr_b16 a[240:241], v12 offset:16384
    ds_read_b64_tr_b16 a[242:243], v12 offset:20480
    v_mfma_f32_16x16x32_bf16 v[200:203], a[252:255], v[160:163], v[200:203]
    v_cvt_pk_bf16_f32 v216, v176, v177
    v_cvt_pk_bf16_f32 v217, v178, v179
    v_mfma_f32_16x16x32_bf16 v[204:207], a[252:255], v[164:167], v[204:207]
    v_exp_f32 v180, v180
    v_mfma_f32_16x16x32_bf16 v[208:211], a[252:255], v[168:171], v[208:211]
    v_exp_f32 v181, v181
    v_mfma_f32_16x16x32_bf16 v[52:55], v[32:35], v[232:235], v[52:55]
    ds_read_b64_tr_b16 a[244:245], v13 offset:16384
    ds_read_b64_tr_b16 a[246:247], v13 offset:20480
    v_mfma_f32_16x16x32_bf16 v[56:59], v[32:35], v[236:239], v[56:59]
    v_exp_f32 v182, v182
    v_mfma_f32_16x16x32_bf16 v[60:63], v[32:35], v[240:243], v[60:63]
    v_exp_f32 v183, v183
    v_mfma_f32_16x16x32_bf16 v[64:67], v[32:35], v[244:247], v[64:67]
    v_cvt_pk_bf16_f32 v220, v180, v181
    v_cvt_pk_bf16_f32 v221, v182, v183
    v_mfma_f32_16x16x32_bf16 v[68:71], v[32:35], v[248:251], v[68:71]
    s_waitcnt lgkmcnt(10)
    ds_read_b64_tr_b16 a[248:249], v14 offset:16384
    ds_read_b64_tr_b16 a[250:251], v14 offset:20480
    v_mfma_f32_16x16x32_bf16 a[0:3], v[36:39], v[232:235], a[0:3]
    v_exp_f32 v184, v184
    v_mfma_f32_16x16x32_bf16 a[4:7], v[36:39], v[236:239], a[4:7]
    v_exp_f32 v185, v185
    v_mfma_f32_16x16x32_bf16 a[8:11], v[36:39], v[240:243], a[8:11]
    v_exp_f32 v186, v186
    v_mfma_f32_16x16x32_bf16 a[12:15], v[36:39], v[244:247], a[12:15]
    ds_read_b64_tr_b16 a[252:253], v15 offset:16384
    ds_read_b64_tr_b16 a[254:255], v15 offset:20480
    v_mfma_f32_16x16x32_bf16 a[16:19], v[36:39], v[248:251], a[16:19]
    s_waitcnt lgkmcnt(12)
    v_exp_f32 v187, v187
    v_mfma_f32_16x16x32_bf16 a[20:23], v[40:43], v[232:235], a[20:23]
    v_cvt_pk_bf16_f32 v224, v184, v185
    v_cvt_pk_bf16_f32 v225, v186, v187
    v_mfma_f32_16x16x32_bf16 a[24:27], v[40:43], v[236:239], a[24:27]
    v_exp_f32 v188, v188
    v_mfma_f32_16x16x32_bf16 a[28:31], v[40:43], v[240:243], a[28:31]
    v_exp_f32 v189, v189
    v_mfma_f32_16x16x32_bf16 a[32:35], v[40:43], v[244:247], a[32:35]
    v_exp_f32 v190, v190
    v_mfma_f32_16x16x32_bf16 a[36:39], v[40:43], v[248:251], a[36:39]
    s_waitcnt lgkmcnt(10)
    v_exp_f32 v191, v191
    v_mfma_f32_16x16x32_bf16 a[40:43], v[44:47], v[232:235], a[40:43]
    v_cvt_pk_bf16_f32 v228, v188, v189
    v_cvt_pk_bf16_f32 v229, v190, v191
    v_mfma_f32_16x16x32_bf16 a[44:47], v[44:47], v[236:239], a[44:47]
    v_exp_f32 v192, v192
    v_mfma_f32_16x16x32_bf16 a[48:51], v[44:47], v[240:243], a[48:51]
    v_exp_f32 v193, v193
    v_mfma_f32_16x16x32_bf16 a[52:55], v[44:47], v[244:247], a[52:55]
    v_exp_f32 v194, v194
    v_mfma_f32_16x16x32_bf16 a[56:59], v[44:47], v[248:251], a[56:59]
    s_waitcnt lgkmcnt(8)
    v_exp_f32 v195, v195
    v_mfma_f32_16x16x32_bf16 a[60:63], v[48:51], v[232:235], a[60:63]
    s_cmp_eq_u32 s36, s101
    v_cvt_pk_bf16_f32 v214, v192, v193
    v_cvt_pk_bf16_f32 v215, v194, v195
    v_mfma_f32_16x16x32_bf16 a[64:67], v[48:51], v[236:239], a[64:67]
    s_cselect_b32 s18, 0, s18
    v_exp_f32 v196, v196
    v_mfma_f32_16x16x32_bf16 a[68:71], v[48:51], v[240:243], a[68:71]
    s_cselect_b32 s22, 0, s22
    v_exp_f32 v197, v197
    v_mfma_f32_16x16x32_bf16 a[72:75], v[48:51], v[244:247], a[72:75]
    v_exp_f32 v198, v198
    v_mfma_f32_16x16x32_bf16 a[76:79], v[48:51], v[248:251], a[76:79]
    s_waitcnt lgkmcnt(6)
    v_exp_f32 v199, v199
    v_mfma_f32_16x16x32_bf16 a[80:83], a[240:243], v[232:235], a[80:83]
    v_cvt_pk_bf16_f32 v218, v196, v197
    v_cvt_pk_bf16_f32 v219, v198, v199
    v_mfma_f32_16x16x32_bf16 a[84:87], a[240:243], v[236:239], a[84:87]
    v_exp_f32 v200, v200
    v_mfma_f32_16x16x32_bf16 a[88:91], a[240:243], v[240:243], a[88:91]
    v_exp_f32 v201, v201
    v_mfma_f32_16x16x32_bf16 a[92:95], a[240:243], v[244:247], a[92:95]
    v_exp_f32 v202, v202
    v_mfma_f32_16x16x32_bf16 a[96:99], a[240:243], v[248:251], a[96:99]
    s_waitcnt lgkmcnt(4)
    v_exp_f32 v203, v203
    v_mfma_f32_16x16x32_bf16 a[100:103], a[244:247], v[232:235], a[100:103]
    s_waitcnt vmcnt(16) lgkmcnt(0)
    s_barrier
    v_mfma_f32_16x16x32_bf16 a[104:107], a[244:247], v[236:239], a[104:107]
    s_add_u32 m0, s39, 32768
    ds_read_b128 v[36:39], v4 offset:49152
    ds_read_b128 v[40:43], v5 offset:49152
    v_mfma_f32_16x16x32_bf16 a[108:111], a[244:247], v[240:243], a[108:111]
    buffer_load_dwordx4 v16, s[16:19], s37 offen offset:0 nt lds
    v_mfma_f32_16x16x32_bf16 a[112:115], a[244:247], v[244:247], a[112:115]
    v_cvt_pk_bf16_f32 v222, v200, v201
    v_cvt_pk_bf16_f32 v223, v202, v203
    v_mfma_f32_16x16x32_bf16 a[116:119], a[244:247], v[248:251], a[116:119]
    v_exp_f32 v204, v204
    v_mfma_f32_16x16x32_bf16 a[120:123], a[248:251], v[232:235], a[120:123]
    ds_read_b128 v[44:47], v6 offset:49152
    v_mfma_f32_16x16x32_bf16 a[124:127], a[248:251], v[236:239], a[124:127]
    v_exp_f32 v205, v205
    v_mfma_f32_16x16x32_bf16 a[128:131], a[248:251], v[240:243], a[128:131]
    v_exp_f32 v206, v206
    v_mfma_f32_16x16x32_bf16 a[132:135], a[248:251], v[244:247], a[132:135]
    buffer_load_dwordx4 v17, s[16:19], s37 offen offset:1024 nt lds
    v_mfma_f32_16x16x32_bf16 a[136:139], a[248:251], v[248:251], a[136:139]
    v_exp_f32 v207, v207
    v_mfma_f32_16x16x32_bf16 a[140:143], a[252:255], v[232:235], a[140:143]
    ds_read_b128 v[48:51], v7 offset:49152
    v_cvt_pk_bf16_f32 v226, v204, v205
    v_mfma_f32_16x16x32_bf16 a[144:147], a[252:255], v[236:239], a[144:147]
    v_cvt_pk_bf16_f32 v227, v206, v207
    v_mfma_f32_16x16x32_bf16 a[148:151], a[252:255], v[240:243], a[148:151]
    v_exp_f32 v208, v208
    v_mfma_f32_16x16x32_bf16 a[152:155], a[252:255], v[244:247], a[152:155]
    v_exp_f32 v209, v209
    v_mfma_f32_16x16x32_bf16 a[156:159], a[252:255], v[248:251], a[156:159]
    s_waitcnt lgkmcnt(3)
    buffer_load_dwordx4 v18, s[16:19], s37 offen offset:2048 nt lds
    v_mfma_f32_16x16x32_bf16 v[172:175], v[36:39], v[92:95], v[72:75]
    ds_read_b128 a[240:243], v4 offset:53248
    v_cvt_pk_bf16_f32 v230, v208, v209
    v_mfma_f32_16x16x32_bf16 v[176:179], v[36:39], v[96:99], v[76:79]
    v_exp_f32 v210, v210
    v_mfma_f32_16x16x32_bf16 v[180:183], v[36:39], v[100:103], v[80:83]
    v_exp_f32 v211, v211
    v_mfma_f32_16x16x32_bf16 v[184:187], v[36:39], v[104:107], v[84:87]
    v_cvt_pk_bf16_f32 v231, v210, v211
    v_mfma_f32_16x16x32_bf16 v[188:191], v[36:39], v[108:111], v[88:91]
    s_waitcnt lgkmcnt(3)
    v_mfma_f32_16x16x32_bf16 v[172:175], v[40:43], v[112:115], v[172:175]
    buffer_load_dwordx4 v19, s[16:19], s37 offen offset:3072 nt lds
    v_mfma_f32_16x16x32_bf16 v[176:179], v[40:43], v[116:119], v[176:179]
    s_add_u32 m0, s39, 24576
    s_add_u32 s37, s37, 8192
    ds_read_b128 a[244:247], v5 offset:53248
    v_mfma_f32_16x16x32_bf16 v[180:183], v[40:43], v[120:123], v[180:183]
    v_mfma_f32_16x16x32_bf16 v[184:187], v[40:43], v[124:127], v[184:187]
    v_mfma_f32_16x16x32_bf16 v[188:191], v[40:43], v[128:131], v[188:191]
    s_waitcnt lgkmcnt(3)
    v_mfma_f32_16x16x32_bf16 v[172:175], v[44:47], v[132:135], v[172:175]
    ds_read_b128 a[248:251], v6 offset:53248
    v_mfma_f32_16x16x32_bf16 v[176:179], v[44:47], v[136:139], v[176:179]
    buffer_load_dwordx4 v16, s[20:23], s38 offen offset:0 nt lds
    v_mfma_f32_16x16x32_bf16 v[180:183], v[44:47], v[140:143], v[180:183]
    v_mfma_f32_16x16x32_bf16 v[184:187], v[44:47], v[144:147], v[184:187]
    v_mfma_f32_16x16x32_bf16 v[188:191], v[44:47], v[148:151], v[188:191]
    s_waitcnt lgkmcnt(3)
    v_mfma_f32_16x16x32_bf16 v[172:175], v[48:51], v[152:155], v[172:175]
    ds_read_b128 a[252:255], v7 offset:53248
    v_mfma_f32_16x16x32_bf16 v[176:179], v[48:51], v[156:159], v[176:179]
    v_mfma_f32_16x16x32_bf16 v[180:183], v[48:51], v[160:163], v[180:183]
    buffer_load_dwordx4 v17, s[20:23], s38 offen offset:1024 nt lds
    v_mfma_f32_16x16x32_bf16 v[184:187], v[48:51], v[164:167], v[184:187]
    v_mfma_f32_16x16x32_bf16 v[188:191], v[48:51], v[168:171], v[188:191]
    s_waitcnt lgkmcnt(3)
    v_mfma_f32_16x16x32_bf16 v[192:195], a[240:243], v[92:95], v[72:75]
    ds_read_b64_tr_b16 v[36:37], v8 offset:32768
    ds_read_b64_tr_b16 v[38:39], v8 offset:36864
    v_mfma_f32_16x16x32_bf16 v[196:199], a[240:243], v[96:99], v[76:79]
    v_mfma_f32_16x16x32_bf16 v[200:203], a[240:243], v[100:103], v[80:83]
    v_exp_f32 v172, v172
    v_mfma_f32_16x16x32_bf16 v[204:207], a[240:243], v[104:107], v[84:87]
    buffer_load_dwordx4 v18, s[20:23], s38 offen offset:2048 nt lds
    v_mfma_f32_16x16x32_bf16 v[208:211], a[240:243], v[108:111], v[88:91]
    s_waitcnt lgkmcnt(4)
    ds_read_b64_tr_b16 v[40:41], v9 offset:32768
    ds_read_b64_tr_b16 v[42:43], v9 offset:36864
    v_mfma_f32_16x16x32_bf16 v[192:195], a[244:247], v[112:115], v[192:195]
    v_exp_f32 v173, v173
    v_mfma_f32_16x16x32_bf16 v[196:199], a[244:247], v[116:119], v[196:199]
    v_exp_f32 v174, v174
    v_mfma_f32_16x16x32_bf16 v[200:203], a[244:247], v[120:123], v[200:203]
    v_exp_f32 v175, v175
    v_mfma_f32_16x16x32_bf16 v[204:207], a[244:247], v[124:127], v[204:207]
    ds_read_b64_tr_b16 v[44:45], v10 offset:32768
    ds_read_b64_tr_b16 v[46:47], v10 offset:36864
    v_mfma_f32_16x16x32_bf16 v[208:211], a[244:247], v[128:131], v[208:211]
    s_waitcnt lgkmcnt(7)
    buffer_load_dwordx4 v19, s[20:23], s38 offen offset:3072 nt lds
    v_mfma_f32_16x16x32_bf16 v[192:195], a[248:251], v[132:135], v[192:195]
    s_add_u32 s38, s38, 8192
    v_cvt_pk_bf16_f32 v232, v172, v173
    v_cvt_pk_bf16_f32 v233, v174, v175
    v_mfma_f32_16x16x32_bf16 v[196:199], a[248:251], v[136:139], v[196:199]
    v_exp_f32 v176, v176
    v_mfma_f32_16x16x32_bf16 v[200:203], a[248:251], v[140:143], v[200:203]
    ds_read_b64_tr_b16 v[48:49], v11 offset:32768
    ds_read_b64_tr_b16 v[50:51], v11 offset:36864
    v_mfma_f32_16x16x32_bf16 v[204:207], a[248:251], v[144:147], v[204:207]
    v_exp_f32 v177, v177
    v_mfma_f32_16x16x32_bf16 v[208:211], a[248:251], v[148:151], v[208:211]
    s_waitcnt lgkmcnt(8)
    v_exp_f32 v178, v178
    v_mfma_f32_16x16x32_bf16 v[192:195], a[252:255], v[152:155], v[192:195]
    v_exp_f32 v179, v179
    v_mfma_f32_16x16x32_bf16 v[196:199], a[252:255], v[156:159], v[196:199]
    ds_read_b64_tr_b16 a[240:241], v12 offset:32768
    ds_read_b64_tr_b16 a[242:243], v12 offset:36864
    v_mfma_f32_16x16x32_bf16 v[200:203], a[252:255], v[160:163], v[200:203]
    v_cvt_pk_bf16_f32 v236, v176, v177
    v_cvt_pk_bf16_f32 v237, v178, v179
    v_mfma_f32_16x16x32_bf16 v[204:207], a[252:255], v[164:167], v[204:207]
    v_exp_f32 v180, v180
    v_mfma_f32_16x16x32_bf16 v[208:211], a[252:255], v[168:171], v[208:211]
    v_exp_f32 v181, v181
    v_mfma_f32_16x16x32_bf16 v[52:55], v[32:35], v[212:215], v[52:55]
    ds_read_b64_tr_b16 a[244:245], v13 offset:32768
    ds_read_b64_tr_b16 a[246:247], v13 offset:36864
    v_mfma_f32_16x16x32_bf16 v[56:59], v[32:35], v[216:219], v[56:59]
    v_exp_f32 v182, v182
    v_mfma_f32_16x16x32_bf16 v[60:63], v[32:35], v[220:223], v[60:63]
    v_exp_f32 v183, v183
    v_mfma_f32_16x16x32_bf16 v[64:67], v[32:35], v[224:227], v[64:67]
    v_cvt_pk_bf16_f32 v240, v180, v181
    v_cvt_pk_bf16_f32 v241, v182, v183
    v_mfma_f32_16x16x32_bf16 v[68:71], v[32:35], v[228:231], v[68:71]
    s_waitcnt lgkmcnt(10)
    ds_read_b64_tr_b16 a[248:249], v14 offset:32768
    ds_read_b64_tr_b16 a[250:251], v14 offset:36864
    v_mfma_f32_16x16x32_bf16 a[0:3], v[36:39], v[212:215], a[0:3]
    v_exp_f32 v184, v184
    v_mfma_f32_16x16x32_bf16 a[4:7], v[36:39], v[216:219], a[4:7]
    v_exp_f32 v185, v185
    v_mfma_f32_16x16x32_bf16 a[8:11], v[36:39], v[220:223], a[8:11]
    v_exp_f32 v186, v186
    v_mfma_f32_16x16x32_bf16 a[12:15], v[36:39], v[224:227], a[12:15]
    ds_read_b64_tr_b16 a[252:253], v15 offset:32768
    ds_read_b64_tr_b16 a[254:255], v15 offset:36864
    v_mfma_f32_16x16x32_bf16 a[16:19], v[36:39], v[228:231], a[16:19]
    s_waitcnt lgkmcnt(12)
    v_exp_f32 v187, v187
    v_mfma_f32_16x16x32_bf16 a[20:23], v[40:43], v[212:215], a[20:23]
    v_cvt_pk_bf16_f32 v244, v184, v185
    v_cvt_pk_bf16_f32 v245, v186, v187
    v_mfma_f32_16x16x32_bf16 a[24:27], v[40:43], v[216:219], a[24:27]
    v_exp_f32 v188, v188
    v_mfma_f32_16x16x32_bf16 a[28:31], v[40:43], v[220:223], a[28:31]
    v_exp_f32 v189, v189
    v_mfma_f32_16x16x32_bf16 a[32:35], v[40:43], v[224:227], a[32:35]
    v_exp_f32 v190, v190
    v_mfma_f32_16x16x32_bf16 a[36:39], v[40:43], v[228:231], a[36:39]
    s_waitcnt lgkmcnt(10)
    v_exp_f32 v191, v191
    v_mfma_f32_16x16x32_bf16 a[40:43], v[44:47], v[212:215], a[40:43]
    v_cvt_pk_bf16_f32 v248, v188, v189
    v_cvt_pk_bf16_f32 v249, v190, v191
    v_mfma_f32_16x16x32_bf16 a[44:47], v[44:47], v[216:219], a[44:47]
    v_exp_f32 v192, v192
    v_mfma_f32_16x16x32_bf16 a[48:51], v[44:47], v[220:223], a[48:51]
    v_exp_f32 v193, v193
    v_mfma_f32_16x16x32_bf16 a[52:55], v[44:47], v[224:227], a[52:55]
    v_exp_f32 v194, v194
    v_mfma_f32_16x16x32_bf16 a[56:59], v[44:47], v[228:231], a[56:59]
    s_waitcnt lgkmcnt(8)
    v_exp_f32 v195, v195
    v_mfma_f32_16x16x32_bf16 a[60:63], v[48:51], v[212:215], a[60:63]
    v_cvt_pk_bf16_f32 v234, v192, v193
    v_cvt_pk_bf16_f32 v235, v194, v195
    v_mfma_f32_16x16x32_bf16 a[64:67], v[48:51], v[216:219], a[64:67]
    v_exp_f32 v196, v196
    v_mfma_f32_16x16x32_bf16 a[68:71], v[48:51], v[220:223], a[68:71]
    v_exp_f32 v197, v197
    v_mfma_f32_16x16x32_bf16 a[72:75], v[48:51], v[224:227], a[72:75]
    v_exp_f32 v198, v198
    v_mfma_f32_16x16x32_bf16 a[76:79], v[48:51], v[228:231], a[76:79]
    s_waitcnt lgkmcnt(6)
    v_exp_f32 v199, v199
    v_mfma_f32_16x16x32_bf16 a[80:83], a[240:243], v[212:215], a[80:83]
    v_cvt_pk_bf16_f32 v238, v196, v197
    v_cvt_pk_bf16_f32 v239, v198, v199
    v_mfma_f32_16x16x32_bf16 a[84:87], a[240:243], v[216:219], a[84:87]
    v_exp_f32 v200, v200
    v_mfma_f32_16x16x32_bf16 a[88:91], a[240:243], v[220:223], a[88:91]
    v_exp_f32 v201, v201
    v_mfma_f32_16x16x32_bf16 a[92:95], a[240:243], v[224:227], a[92:95]
    v_exp_f32 v202, v202
    v_mfma_f32_16x16x32_bf16 a[96:99], a[240:243], v[228:231], a[96:99]
    s_waitcnt lgkmcnt(4)
    v_exp_f32 v203, v203
    v_mfma_f32_16x16x32_bf16 a[100:103], a[244:247], v[212:215], a[100:103]
    s_waitcnt vmcnt(16) lgkmcnt(0)
    s_barrier
    v_mfma_f32_16x16x32_bf16 a[104:107], a[244:247], v[216:219], a[104:107]
    s_add_u32 m0, s39, 49152
    ds_read_b128 v[36:39], v4 offset:0
    ds_read_b128 v[40:43], v5 offset:0
    v_mfma_f32_16x16x32_bf16 a[108:111], a[244:247], v[220:223], a[108:111]
    buffer_load_dwordx4 v16, s[16:19], s37 offen offset:0 nt lds
    v_mfma_f32_16x16x32_bf16 a[112:115], a[244:247], v[224:227], a[112:115]
    v_cvt_pk_bf16_f32 v242, v200, v201
    v_cvt_pk_bf16_f32 v243, v202, v203
    v_mfma_f32_16x16x32_bf16 a[116:119], a[244:247], v[228:231], a[116:119]
    v_exp_f32 v204, v204
    v_mfma_f32_16x16x32_bf16 a[120:123], a[248:251], v[212:215], a[120:123]
    ds_read_b128 v[44:47], v6 offset:0
    v_mfma_f32_16x16x32_bf16 a[124:127], a[248:251], v[216:219], a[124:127]
    v_exp_f32 v205, v205
    v_mfma_f32_16x16x32_bf16 a[128:131], a[248:251], v[220:223], a[128:131]
    v_exp_f32 v206, v206
    v_mfma_f32_16x16x32_bf16 a[132:135], a[248:251], v[224:227], a[132:135]
    buffer_load_dwordx4 v17, s[16:19], s37 offen offset:1024 nt lds
    v_mfma_f32_16x16x32_bf16 a[136:139], a[248:251], v[228:231], a[136:139]
    v_exp_f32 v207, v207
    v_mfma_f32_16x16x32_bf16 a[140:143], a[252:255], v[212:215], a[140:143]
    ds_read_b128 v[48:51], v7 offset:0
    v_cvt_pk_bf16_f32 v246, v204, v205
    v_mfma_f32_16x16x32_bf16 a[144:147], a[252:255], v[216:219], a[144:147]
    v_cvt_pk_bf16_f32 v247, v206, v207
    v_mfma_f32_16x16x32_bf16 a[148:151], a[252:255], v[220:223], a[148:151]
    v_exp_f32 v208, v208
    v_mfma_f32_16x16x32_bf16 a[152:155], a[252:255], v[224:227], a[152:155]
    v_exp_f32 v209, v209
    v_mfma_f32_16x16x32_bf16 a[156:159], a[252:255], v[228:231], a[156:159]
    s_waitcnt lgkmcnt(3)
    buffer_load_dwordx4 v18, s[16:19], s37 offen offset:2048 nt lds
    s_cmp_eq_u32 s36, 3
    s_cbranch_scc1 L_atail
    v_mfma_f32_16x16x32_bf16 v[172:175], v[36:39], v[92:95], v[72:75]
    ds_read_b128 a[240:243], v4 offset:4096
    v_cvt_pk_bf16_f32 v250, v208, v209
    v_mfma_f32_16x16x32_bf16 v[176:179], v[36:39], v[96:99], v[76:79]
    v_exp_f32 v210, v210
    v_mfma_f32_16x16x32_bf16 v[180:183], v[36:39], v[100:103], v[80:83]
    v_exp_f32 v211, v211
    v_mfma_f32_16x16x32_bf16 v[184:187], v[36:39], v[104:107], v[84:87]
    v_cvt_pk_bf16_f32 v251, v210, v211
    v_mfma_f32_16x16x32_bf16 v[188:191], v[36:39], v[108:111], v[88:91]
    s_waitcnt lgkmcnt(3)
    v_mfma_f32_16x16x32_bf16 v[172:175], v[40:43], v[112:115], v[172:175]
    buffer_load_dwordx4 v19, s[16:19], s37 offen offset:3072 nt lds
    v_mfma_f32_16x16x32_bf16 v[176:179], v[40:43], v[116:119], v[176:179]
    s_add_u32 m0, s39, 40960
    s_add_u32 s37, s37, 8192
    ds_read_b128 a[244:247], v5 offset:4096
    v_mfma_f32_16x16x32_bf16 v[180:183], v[40:43], v[120:123], v[180:183]
    v_mfma_f32_16x16x32_bf16 v[184:187], v[40:43], v[124:127], v[184:187]
    v_mfma_f32_16x16x32_bf16 v[188:191], v[40:43], v[128:131], v[188:191]
    s_waitcnt lgkmcnt(3)
    v_mfma_f32_16x16x32_bf16 v[172:175], v[44:47], v[132:135], v[172:175]
    ds_read_b128 a[248:251], v6 offset:4096
    v_mfma_f32_16x16x32_bf16 v[176:179], v[44:47], v[136:139], v[176:179]
    buffer_load_dwordx4 v16, s[20:23], s38 offen offset:0 nt lds
    v_mfma_f32_16x16x32_bf16 v[180:183], v[44:47], v[140:143], v[180:183]
    v_mfma_f32_16x16x32_bf16 v[184:187], v[44:47], v[144:147], v[184:187]
    v_mfma_f32_16x16x32_bf16 v[188:191], v[44:47], v[148:151], v[188:191]
    s_waitcnt lgkmcnt(3)
    v_mfma_f32_16x16x32_bf16 v[172:175], v[48:51], v[152:155], v[172:175]
    ds_read_b128 a[252:255], v7 offset:4096
    v_mfma_f32_16x16x32_bf16 v[176:179], v[48:51], v[156:159], v[176:179]
    v_mfma_f32_16x16x32_bf16 v[180:183], v[48:51], v[160:163], v[180:183]
    buffer_load_dwordx4 v17, s[20:23], s38 offen offset:1024 nt lds
    v_mfma_f32_16x16x32_bf16 v[184:187], v[48:51], v[164:167], v[184:187]
    v_mfma_f32_16x16x32_bf16 v[188:191], v[48:51], v[168:171], v[188:191]
    s_waitcnt lgkmcnt(3)
    v_mfma_f32_16x16x32_bf16 v[192:195], a[240:243], v[92:95], v[72:75]
    ds_read_b64_tr_b16 v[36:37], v8 offset:49152
    ds_read_b64_tr_b16 v[38:39], v8 offset:53248
    v_mfma_f32_16x16x32_bf16 v[196:199], a[240:243], v[96:99], v[76:79]
    v_mfma_f32_16x16x32_bf16 v[200:203], a[240:243], v[100:103], v[80:83]
    v_exp_f32 v172, v172
    v_mfma_f32_16x16x32_bf16 v[204:207], a[240:243], v[104:107], v[84:87]
    buffer_load_dwordx4 v18, s[20:23], s38 offen offset:2048 nt lds
    v_mfma_f32_16x16x32_bf16 v[208:211], a[240:243], v[108:111], v[88:91]
    s_waitcnt lgkmcnt(4)
    ds_read_b64_tr_b16 v[40:41], v9 offset:49152
    ds_read_b64_tr_b16 v[42:43], v9 offset:53248
    v_mfma_f32_16x16x32_bf16 v[192:195], a[244:247], v[112:115], v[192:195]
    v_exp_f32 v173, v173
    v_mfma_f32_16x16x32_bf16 v[196:199], a[244:247], v[116:119], v[196:199]
    v_exp_f32 v174, v174
    v_mfma_f32_16x16x32_bf16 v[200:203], a[244:247], v[120:123], v[200:203]
    v_exp_f32 v175, v175
    v_mfma_f32_16x16x32_bf16 v[204:207], a[244:247], v[124:127], v[204:207]
    ds_read_b64_tr_b16 v[44:45], v10 offset:49152
    ds_read_b64_tr_b16 v[46:47], v10 offset:53248
    v_mfma_f32_16x16x32_bf16 v[208:211], a[244:247], v[128:131], v[208:211]
    s_waitcnt lgkmcnt(7)
    buffer_load_dwordx4 v19, s[20:23], s38 offen offset:3072 nt lds
    v_mfma_f32_16x16x32_bf16 v[192:195], a[248:251], v[132:135], v[192:195]
    s_add_u32 s38, s38, 8192
    v_cvt_pk_bf16_f32 v212, v172, v173
    v_cvt_pk_bf16_f32 v213, v174, v175
    v_mfma_f32_16x16x32_bf16 v[196:199], a[248:251], v[136:139], v[196:199]
    v_exp_f32 v176, v176
    v_mfma_f32_16x16x32_bf16 v[200:203], a[248:251], v[140:143], v[200:203]
    ds_read_b64_tr_b16 v[48:49], v11 offset:49152
    ds_read_b64_tr_b16 v[50:51], v11 offset:53248
    v_mfma_f32_16x16x32_bf16 v[204:207], a[248:251], v[144:147], v[204:207]
    v_exp_f32 v177, v177
    v_mfma_f32_16x16x32_bf16 v[208:211], a[248:251], v[148:151], v[208:211]
    s_waitcnt lgkmcnt(8)
    v_exp_f32 v178, v178
    v_mfma_f32_16x16x32_bf16 v[192:195], a[252:255], v[152:155], v[192:195]
    v_exp_f32 v179, v179
    v_mfma_f32_16x16x32_bf16 v[196:199], a[252:255], v[156:159], v[196:199]
    ds_read_b64_tr_b16 a[240:241], v12 offset:49152
    ds_read_b64_tr_b16 a[242:243], v12 offset:53248
    v_mfma_f32_16x16x32_bf16 v[200:203], a[252:255], v[160:163], v[200:203]
    v_cvt_pk_bf16_f32 v216, v176, v177
    v_cvt_pk_bf16_f32 v217, v178, v179
    v_mfma_f32_16x16x32_bf16 v[204:207], a[252:255], v[164:167], v[204:207]
    v_exp_f32 v180, v180
    v_mfma_f32_16x16x32_bf16 v[208:211], a[252:255], v[168:171], v[208:211]
    v_exp_f32 v181, v181
    v_mfma_f32_16x16x32_bf16 v[52:55], v[32:35], v[232:235], v[52:55]
    ds_read_b64_tr_b16 a[244:245], v13 offset:49152
    ds_read_b64_tr_b16 a[246:247], v13 offset:53248
    v_mfma_f32_16x16x32_bf16 v[56:59], v[32:35], v[236:239], v[56:59]
    v_exp_f32 v182, v182
    v_mfma_f32_16x16x32_bf16 v[60:63], v[32:35], v[240:243], v[60:63]
    v_exp_f32 v183, v183
    v_mfma_f32_16x16x32_bf16 v[64:67], v[32:35], v[244:247], v[64:67]
    v_cvt_pk_bf16_f32 v220, v180, v181
    v_cvt_pk_bf16_f32 v221, v182, v183
    v_mfma_f32_16x16x32_bf16 v[68:71], v[32:35], v[248:251], v[68:71]
    s_waitcnt lgkmcnt(10)
    ds_read_b64_tr_b16 a[248:249], v14 offset:49152
    ds_read_b64_tr_b16 a[250:251], v14 offset:53248
    v_mfma_f32_16x16x32_bf16 a[0:3], v[36:39], v[232:235], a[0:3]
    v_exp_f32 v184, v184
    v_mfma_f32_16x16x32_bf16 a[4:7], v[36:39], v[236:239], a[4:7]
    v_exp_f32 v185, v185
    v_mfma_f32_16x16x32_bf16 a[8:11], v[36:39], v[240:243], a[8:11]
    v_exp_f32 v186, v186
    v_mfma_f32_16x16x32_bf16 a[12:15], v[36:39], v[244:247], a[12:15]
    ds_read_b64_tr_b16 a[252:253], v15 offset:49152
    ds_read_b64_tr_b16 a[254:255], v15 offset:53248
    v_mfma_f32_16x16x32_bf16 a[16:19], v[36:39], v[248:251], a[16:19]
    s_waitcnt lgkmcnt(12)
    v_exp_f32 v187, v187
    v_mfma_f32_16x16x32_bf16 a[20:23], v[40:43], v[232:235], a[20:23]
    v_cvt_pk_bf16_f32 v224, v184, v185
    v_cvt_pk_bf16_f32 v225, v186, v187
    v_mfma_f32_16x16x32_bf16 a[24:27], v[40:43], v[236:239], a[24:27]
    v_exp_f32 v188, v188
    v_mfma_f32_16x16x32_bf16 a[28:31], v[40:43], v[240:243], a[28:31]
    v_exp_f32 v189, v189
    v_mfma_f32_16x16x32_bf16 a[32:35], v[40:43], v[244:247], a[32:35]
    v_exp_f32 v190, v190
    v_mfma_f32_16x16x32_bf16 a[36:39], v[40:43], v[248:251], a[36:39]
    s_waitcnt lgkmcnt(10)
    v_exp_f32 v191, v191
    v_mfma_f32_16x16x32_bf16 a[40:43], v[44:47], v[232:235], a[40:43]
    v_cvt_pk_bf16_f32 v228, v188, v189
    v_cvt_pk_bf16_f32 v229, v190, v191
    v_mfma_f32_16x16x32_bf16 a[44:47], v[44:47], v[236:239], a[44:47]
    v_exp_f32 v192, v192
    v_mfma_f32_16x16x32_bf16 a[48:51], v[44:47], v[240:243], a[48:51]
    v_exp_f32 v193, v193
    v_mfma_f32_16x16x32_bf16 a[52:55], v[44:47], v[244:247], a[52:55]
    v_exp_f32 v194, v194
    v_mfma_f32_16x16x32_bf16 a[56:59], v[44:47], v[248:251], a[56:59]
    s_waitcnt lgkmcnt(8)
    v_exp_f32 v195, v195
    v_mfma_f32_16x16x32_bf16 a[60:63], v[48:51], v[232:235], a[60:63]
    v_cvt_pk_bf16_f32 v214, v192, v193
    v_cvt_pk_bf16_f32 v215, v194, v195
    v_mfma_f32_16x16x32_bf16 a[64:67], v[48:51], v[236:239], a[64:67]
    v_exp_f32 v196, v196
    v_mfma_f32_16x16x32_bf16 a[68:71], v[48:51], v[240:243], a[68:71]
    v_exp_f32 v197, v197
    v_mfma_f32_16x16x32_bf16 a[72:75], v[48:51], v[244:247], a[72:75]
    v_exp_f32 v198, v198
    v_mfma_f32_16x16x32_bf16 a[76:79], v[48:51], v[248:251], a[76:79]
    s_waitcnt lgkmcnt(6)
    v_exp_f32 v199, v199
    v_mfma_f32_16x16x32_bf16 a[80:83], a[240:243], v[232:235], a[80:83]
    v_cvt_pk_bf16_f32 v218, v196, v197
    v_cvt_pk_bf16_f32 v219, v198, v199
    v_mfma_f32_16x16x32_bf16 a[84:87], a[240:243], v[236:239], a[84:87]
    v_exp_f32 v200, v200
    v_mfma_f32_16x16x32_bf16 a[88:91], a[240:243], v[240:243], a[88:91]
    v_exp_f32 v201, v201
    v_mfma_f32_16x16x32_bf16 a[92:95], a[240:243], v[244:247], a[92:95]
    v_exp_f32 v202, v202
    v_mfma_f32_16x16x32_bf16 a[96:99], a[240:243], v[248:251], a[96:99]
    s_waitcnt lgkmcnt(4)
    v_exp_f32 v203, v203
    v_mfma_f32_16x16x32_bf16 a[100:103], a[244:247], v[232:235], a[100:103]
    s_waitcnt vmcnt(16) lgkmcnt(0)
    s_barrier
    v_mfma_f32_16x16x32_bf16 a[104:107], a[244:247], v[236:239], a[104:107]
    s_add_u32 m0, s39, 0
    ds_read_b128 v[36:39], v4 offset:16384
    ds_read_b128 v[40:43], v5 offset:16384
    v_mfma_f32_16x16x32_bf16 a[108:111], a[244:247], v[240:243], a[108:111]
    buffer_load_dwordx4 v16, s[16:19], s37 offen offset:0 nt lds
    v_mfma_f32_16x16x32_bf16 a[112:115], a[244:247], v[244:247], a[112:115]
    v_cvt_pk_bf16_f32 v222, v200, v201
    v_cvt_pk_bf16_f32 v223, v202, v203
    v_mfma_f32_16x16x32_bf16 a[116:119], a[244:247], v[248:251], a[116:119]
    v_exp_f32 v204, v204
    v_mfma_f32_16x16x32_bf16 a[120:123], a[248:251], v[232:235], a[120:123]
    ds_read_b128 v[44:47], v6 offset:16384
    v_mfma_f32_16x16x32_bf16 a[124:127], a[248:251], v[236:239], a[124:127]
    v_exp_f32 v205, v205
    v_mfma_f32_16x16x32_bf16 a[128:131], a[248:251], v[240:243], a[128:131]
    v_exp_f32 v206, v206
    v_mfma_f32_16x16x32_bf16 a[132:135], a[248:251], v[244:247], a[132:135]
    buffer_load_dwordx4 v17, s[16:19], s37 offen offset:1024 nt lds
    v_mfma_f32_16x16x32_bf16 a[136:139], a[248:251], v[248:251], a[136:139]
    v_exp_f32 v207, v207
    v_mfma_f32_16x16x32_bf16 a[140:143], a[252:255], v[232:235], a[140:143]
    ds_read_b128 v[48:51], v7 offset:16384
    v_cvt_pk_bf16_f32 v226, v204, v205
    v_mfma_f32_16x16x32_bf16 a[144:147], a[252:255], v[236:239], a[144:147]
    v_cvt_pk_bf16_f32 v227, v206, v207
    v_mfma_f32_16x16x32_bf16 a[148:151], a[252:255], v[240:243], a[148:151]
    v_exp_f32 v208, v208
    v_mfma_f32_16x16x32_bf16 a[152:155], a[252:255], v[244:247], a[152:155]
    v_exp_f32 v209, v209
    v_mfma_f32_16x16x32_bf16 a[156:159], a[252:255], v[248:251], a[156:159]
    s_waitcnt lgkmcnt(3)
    buffer_load_dwordx4 v18, s[16:19], s37 offen offset:2048 nt lds
    v_mfma_f32_16x16x32_bf16 v[172:175], v[36:39], v[92:95], v[72:75]
    ds_read_b128 a[240:243], v4 offset:20480
    v_cvt_pk_bf16_f32 v230, v208, v209
    v_mfma_f32_16x16x32_bf16 v[176:179], v[36:39], v[96:99], v[76:79]
    v_exp_f32 v210, v210
    v_mfma_f32_16x16x32_bf16 v[180:183], v[36:39], v[100:103], v[80:83]
    v_exp_f32 v211, v211
    v_mfma_f32_16x16x32_bf16 v[184:187], v[36:39], v[104:107], v[84:87]
    v_cvt_pk_bf16_f32 v231, v210, v211
    v_mfma_f32_16x16x32_bf16 v[188:191], v[36:39], v[108:111], v[88:91]
    s_waitcnt lgkmcnt(3)
    v_mfma_f32_16x16x32_bf16 v[172:175], v[40:43], v[112:115], v[172:175]
    buffer_load_dwordx4 v19, s[16:19], s37 offen offset:3072 nt lds
    v_mfma_f32_16x16x32_bf16 v[176:179], v[40:43], v[116:119], v[176:179]
    s_add_u32 m0, s39, 57344
    s_add_u32 s37, s37, 8192
    ds_read_b128 a[244:247], v5 offset:20480
    v_mfma_f32_16x16x32_bf16 v[180:183], v[40:43], v[120:123], v[180:183]
    v_mfma_f32_16x16x32_bf16 v[184:187], v[40:43], v[124:127], v[184:187]
    v_mfma_f32_16x16x32_bf16 v[188:191], v[40:43], v[128:131], v[188:191]
    s_waitcnt lgkmcnt(3)
    v_mfma_f32_16x16x32_bf16 v[172:175], v[44:47], v[132:135], v[172:175]
    ds_read_b128 a[248:251], v6 offset:20480
    v_mfma_f32_16x16x32_bf16 v[176:179], v[44:47], v[136:139], v[176:179]
    buffer_load_dwordx4 v16, s[20:23], s38 offen offset:0 nt lds
    v_mfma_f32_16x16x32_bf16 v[180:183], v[44:47], v[140:143], v[180:183]
    v_mfma_f32_16x16x32_bf16 v[184:187], v[44:47], v[144:147], v[184:187]
    v_mfma_f32_16x16x32_bf16 v[188:191], v[44:47], v[148:151], v[188:191]
    s_waitcnt lgkmcnt(3)
    v_mfma_f32_16x16x32_bf16 v[172:175], v[48:51], v[152:155], v[172:175]
    ds_read_b128 a[252:255], v7 offset:20480
    v_mfma_f32_16x16x32_bf16 v[176:179], v[48:51], v[156:159], v[176:179]
    v_mfma_f32_16x16x32_bf16 v[180:183], v[48:51], v[160:163], v[180:183]
    buffer_load_dwordx4 v17, s[20:23], s38 offen offset:1024 nt lds
    v_mfma_f32_16x16x32_bf16 v[184:187], v[48:51], v[164:167], v[184:187]
    v_mfma_f32_16x16x32_bf16 v[188:191], v[48:51], v[168:171], v[188:191]
    s_waitcnt lgkmcnt(3)
    v_mfma_f32_16x16x32_bf16 v[192:195], a[240:243], v[92:95], v[72:75]
    ds_read_b64_tr_b16 v[36:37], v8 offset:0
    ds_read_b64_tr_b16 v[38:39], v8 offset:4096
    v_mfma_f32_16x16x32_bf16 v[196:199], a[240:243], v[96:99], v[76:79]
    v_mfma_f32_16x16x32_bf16 v[200:203], a[240:243], v[100:103], v[80:83]
    v_exp_f32 v172, v172
    v_mfma_f32_16x16x32_bf16 v[204:207], a[240:243], v[104:107], v[84:87]
    buffer_load_dwordx4 v18, s[20:23], s38 offen offset:2048 nt lds
    v_mfma_f32_16x16x32_bf16 v[208:211], a[240:243], v[108:111], v[88:91]
    s_waitcnt lgkmcnt(4)
    ds_read_b64_tr_b16 v[40:41], v9 offset:0
    ds_read_b64_tr_b16 v[42:43], v9 offset:4096
    v_mfma_f32_16x16x32_bf16 v[192:195], a[244:247], v[112:115], v[192:195]
    v_exp_f32 v173, v173
    v_mfma_f32_16x16x32_bf16 v[196:199], a[244:247], v[116:119], v[196:199]
    v_exp_f32 v174, v174
    v_mfma_f32_16x16x32_bf16 v[200:203], a[244:247], v[120:123], v[200:203]
    v_exp_f32 v175, v175
    v_mfma_f32_16x16x32_bf16 v[204:207], a[244:247], v[124:127], v[204:207]
    ds_read_b64_tr_b16 v[44:45], v10 offset:0
    ds_read_b64_tr_b16 v[46:47], v10 offset:4096
    v_mfma_f32_16x16x32_bf16 v[208:211], a[244:247], v[128:131], v[208:211]
    s_waitcnt lgkmcnt(7)
    buffer_load_dwordx4 v19, s[20:23], s38 offen offset:3072 nt lds
    v_mfma_f32_16x16x32_bf16 v[192:195], a[248:251], v[132:135], v[192:195]
    s_add_u32 s38, s38, 8192
    v_cvt_pk_bf16_f32 v232, v172, v173
    v_cvt_pk_bf16_f32 v233, v174, v175
    v_mfma_f32_16x16x32_bf16 v[196:199], a[248:251], v[136:139], v[196:199]
    v_exp_f32 v176, v176
    v_mfma_f32_16x16x32_bf16 v[200:203], a[248:251], v[140:143], v[200:203]
    ds_read_b64_tr_b16 v[48:49], v11 offset:0
    ds_read_b64_tr_b16 v[50:51], v11 offset:4096
    v_mfma_f32_16x16x32_bf16 v[204:207], a[248:251], v[144:147], v[204:207]
    v_exp_f32 v177, v177
    v_mfma_f32_16x16x32_bf16 v[208:211], a[248:251], v[148:151], v[208:211]
    s_waitcnt lgkmcnt(8)
    v_exp_f32 v178, v178
    v_mfma_f32_16x16x32_bf16 v[192:195], a[252:255], v[152:155], v[192:195]
    v_exp_f32 v179, v179
    v_mfma_f32_16x16x32_bf16 v[196:199], a[252:255], v[156:159], v[196:199]
    ds_read_b64_tr_b16 a[240:241], v12 offset:0
    ds_read_b64_tr_b16 a[242:243], v12 offset:4096
    v_mfma_f32_16x16x32_bf16 v[200:203], a[252:255], v[160:163], v[200:203]
    v_cvt_pk_bf16_f32 v236, v176, v177
    v_cvt_pk_bf16_f32 v237, v178, v179
    v_mfma_f32_16x16x32_bf16 v[204:207], a[252:255], v[164:167], v[204:207]
    v_exp_f32 v180, v180
    v_mfma_f32_16x16x32_bf16 v[208:211], a[252:255], v[168:171], v[208:211]
    v_exp_f32 v181, v181
    v_mfma_f32_16x16x32_bf16 v[52:55], v[32:35], v[212:215], v[52:55]
    ds_read_b64_tr_b16 a[244:245], v13 offset:0
    ds_read_b64_tr_b16 a[246:247], v13 offset:4096
    v_mfma_f32_16x16x32_bf16 v[56:59], v[32:35], v[216:219], v[56:59]
    v_exp_f32 v182, v182
    v_mfma_f32_16x16x32_bf16 v[60:63], v[32:35], v[220:223], v[60:63]
    v_exp_f32 v183, v183
    v_mfma_f32_16x16x32_bf16 v[64:67], v[32:35], v[224:227], v[64:67]
    v_cvt_pk_bf16_f32 v240, v180, v181
    v_cvt_pk_bf16_f32 v241, v182, v183
    v_mfma_f32_16x16x32_bf16 v[68:71], v[32:35], v[228:231], v[68:71]
    s_waitcnt lgkmcnt(10)
    ds_read_b64_tr_b16 a[248:249], v14 offset:0
    ds_read_b64_tr_b16 a[250:251], v14 offset:4096
    v_mfma_f32_16x16x32_bf16 a[0:3], v[36:39], v[212:215], a[0:3]
    v_exp_f32 v184, v184
    v_mfma_f32_16x16x32_bf16 a[4:7], v[36:39], v[216:219], a[4:7]
    v_exp_f32 v185, v185
    v_mfma_f32_16x16x32_bf16 a[8:11], v[36:39], v[220:223], a[8:11]
    v_exp_f32 v186, v186
    v_mfma_f32_16x16x32_bf16 a[12:15], v[36:39], v[224:227], a[12:15]
    ds_read_b64_tr_b16 a[252:253], v15 offset:0
    ds_read_b64_tr_b16 a[254:255], v15 offset:4096
    v_mfma_f32_16x16x32_bf16 a[16:19], v[36:39], v[228:231], a[16:19]
    s_waitcnt lgkmcnt(12)
    v_exp_f32 v187, v187
    v_mfma_f32_16x16x32_bf16 a[20:23], v[40:43], v[212:215], a[20:23]
    v_cvt_pk_bf16_f32 v244, v184, v185
    v_cvt_pk_bf16_f32 v245, v186, v187
    v_mfma_f32_16x16x32_bf16 a[24:27], v[40:43], v[216:219], a[24:27]
    v_exp_f32 v188, v188
    v_mfma_f32_16x16x32_bf16 a[28:31], v[40:43], v[220:223], a[28:31]
    v_exp_f32 v189, v189
    v_mfma_f32_16x16x32_bf16 a[32:35], v[40:43], v[224:227], a[32:35]
    v_exp_f32 v190, v190
    v_mfma_f32_16x16x32_bf16 a[36:39], v[40:43], v[228:231], a[36:39]
    s_waitcnt lgkmcnt(10)
    v_exp_f32 v191, v191
    v_mfma_f32_16x16x32_bf16 a[40:43], v[44:47], v[212:215], a[40:43]
    v_cvt_pk_bf16_f32 v248, v188, v189
    v_cvt_pk_bf16_f32 v249, v190, v191
    v_mfma_f32_16x16x32_bf16 a[44:47], v[44:47], v[216:219], a[44:47]
    v_exp_f32 v192, v192
    v_mfma_f32_16x16x32_bf16 a[48:51], v[44:47], v[220:223], a[48:51]
    v_exp_f32 v193, v193
    v_mfma_f32_16x16x32_bf16 a[52:55], v[44:47], v[224:227], a[52:55]
    v_exp_f32 v194, v194
    v_mfma_f32_16x16x32_bf16 a[56:59], v[44:47], v[228:231], a[56:59]
    s_waitcnt lgkmcnt(8)
    v_exp_f32 v195, v195
    v_mfma_f32_16x16x32_bf16 a[60:63], v[48:51], v[212:215], a[60:63]
    v_cvt_pk_bf16_f32 v234, v192, v193
    v_cvt_pk_bf16_f32 v235, v194, v195
    v_mfma_f32_16x16x32_bf16 a[64:67], v[48:51], v[216:219], a[64:67]
    v_exp_f32 v196, v196
    v_mfma_f32_16x16x32_bf16 a[68:71], v[48:51], v[220:223], a[68:71]
    v_exp_f32 v197, v197
    v_mfma_f32_16x16x32_bf16 a[72:75], v[48:51], v[224:227], a[72:75]
    v_exp_f32 v198, v198
    v_mfma_f32_16x16x32_bf16 a[76:79], v[48:51], v[228:231], a[76:79]
    s_waitcnt lgkmcnt(6)
    v_exp_f32 v199, v199
    v_mfma_f32_16x16x32_bf16 a[80:83], a[240:243], v[212:215], a[80:83]
    v_cvt_pk_bf16_f32 v238, v196, v197
    v_cvt_pk_bf16_f32 v239, v198, v199
    v_mfma_f32_16x16x32_bf16 a[84:87], a[240:243], v[216:219], a[84:87]
    v_exp_f32 v200, v200
    v_mfma_f32_16x16x32_bf16 a[88:91], a[240:243], v[220:223], a[88:91]
    v_exp_f32 v201, v201
    v_mfma_f32_16x16x32_bf16 a[92:95], a[240:243], v[224:227], a[92:95]
    v_exp_f32 v202, v202
    v_mfma_f32_16x16x32_bf16 a[96:99], a[240:243], v[228:231], a[96:99]
    s_waitcnt lgkmcnt(4)
    v_exp_f32 v203, v203
    v_mfma_f32_16x16x32_bf16 a[100:103], a[244:247], v[212:215], a[100:103]
    s_waitcnt vmcnt(16) lgkmcnt(0)
    s_barrier
    v_mfma_f32_16x16x32_bf16 a[104:107], a[244:247], v[216:219], a[104:107]
    s_add_u32 m0, s39, 16384
    ds_read_b128 v[36:39], v4 offset:32768
    ds_read_b128 v[40:43], v5 offset:32768
    v_mfma_f32_16x16x32_bf16 a[108:111], a[244:247], v[220:223], a[108:111]
    buffer_load_dwordx4 v16, s[16:19], s37 offen offset:0 nt lds
    v_mfma_f32_16x16x32_bf16 a[112:115], a[244:247], v[224:227], a[112:115]
    v_cvt_pk_bf16_f32 v242, v200, v201
    v_cvt_pk_bf16_f32 v243, v202, v203
    v_mfma_f32_16x16x32_bf16 a[116:119], a[244:247], v[228:231], a[116:119]
    v_exp_f32 v204, v204
    v_mfma_f32_16x16x32_bf16 a[120:123], a[248:251], v[212:215], a[120:123]
    ds_read_b128 v[44:47], v6 offset:32768
    v_mfma_f32_16x16x32_bf16 a[124:127], a[248:251], v[216:219], a[124:127]
    v_exp_f32 v205, v205
    v_mfma_f32_16x16x32_bf16 a[128:131], a[248:251], v[220:223], a[128:131]
    v_exp_f32 v206, v206
    v_mfma_f32_16x16x32_bf16 a[132:135], a[248:251], v[224:227], a[132:135]
    buffer_load_dwordx4 v17, s[16:19], s37 offen offset:1024 nt lds
    v_mfma_f32_16x16x32_bf16 a[136:139], a[248:251], v[228:231], a[136:139]
    v_exp_f32 v207, v207
    v_mfma_f32_16x16x32_bf16 a[140:143], a[252:255], v[212:215], a[140:143]
    ds_read_b128 v[48:51], v7 offset:32768
    v_cvt_pk_bf16_f32 v246, v204, v205
    v_mfma_f32_16x16x32_bf16 a[144:147], a[252:255], v[216:219], a[144:147]
    v_cvt_pk_bf16_f32 v247, v206, v207
    v_mfma_f32_16x16x32_bf16 a[148:151], a[252:255], v[220:223], a[148:151]
    v_exp_f32 v208, v208
    v_mfma_f32_16x16x32_bf16 a[152:155], a[252:255], v[224:227], a[152:155]
    v_exp_f32 v209, v209
    v_mfma_f32_16x16x32_bf16 a[156:159], a[252:255], v[228:231], a[156:159]
    s_waitcnt lgkmcnt(3)
    buffer_load_dwordx4 v18, s[16:19], s37 offen offset:2048 nt lds
    s_add_u32 s36, s36, 1
    s_branch L_aloop
L_atail:
    s_cmp_eq_u32 s35, 1
    s_cbranch_scc1 L_atail1
    v_cvt_pk_bf16_f32 v250, v208, v209
    v_exp_f32 v210, v210
    v_exp_f32 v211, v211
    s_nop 0
    v_cvt_pk_bf16_f32 v251, v210, v211
    s_waitcnt lgkmcnt(3)
    ds_read_b64_tr_b16 v[36:37], v8 offset:49152
    ds_read_b64_tr_b16 v[38:39], v8 offset:53248
    s_waitcnt lgkmcnt(3)
    ds_read_b64_tr_b16 v[40:41], v9 offset:49152
    ds_read_b64_tr_b16 v[42:43], v9 offset:53248
    ds_read_b64_tr_b16 v[44:45], v10 offset:49152
    ds_read_b64_tr_b16 v[46:47], v10 offset:53248
    s_waitcnt lgkmcnt(6)
    ds_read_b64_tr_b16 v[48:49], v11 offset:49152
    ds_read_b64_tr_b16 v[50:51], v11 offset:53248
    ds_read_b64_tr_b16 a[240:241], v12 offset:49152
    ds_read_b64_tr_b16 a[242:243], v12 offset:53248
    v_mfma_f32_16x16x32_bf16 v[52:55], v[32:35], v[232:235], v[52:55]
    ds_read_b64_tr_b16 a[244:245], v13 offset:49152
    ds_read_b64_tr_b16 a[246:247], v13 offset:53248
    v_mfma_f32_16x16x32_bf16 v[56:59], v[32:35], v[236:239], v[56:59]
    v_mfma_f32_16x16x32_bf16 v[60:63], v[32:35], v[240:243], v[60:63]
    v_mfma_f32_16x16x32_bf16 v[64:67], v[32:35], v[244:247], v[64:67]
    v_mfma_f32_16x16x32_bf16 v[68:71], v[32:35], v[248:251], v[68:71]
    s_waitcnt lgkmcnt(10)
    ds_read_b64_tr_b16 a[248:249], v14 offset:49152
    ds_read_b64_tr_b16 a[250:251], v14 offset:53248
    v_mfma_f32_16x16x32_bf16 a[0:3], v[36:39], v[232:235], a[0:3]
    v_mfma_f32_16x16x32_bf16 a[4:7], v[36:39], v[236:239], a[4:7]
    v_mfma_f32_16x16x32_bf16 a[8:11], v[36:39], v[240:243], a[8:11]
    v_mfma_f32_16x16x32_bf16 a[12:15], v[36:39], v[244:247], a[12:15]
    ds_read_b64_tr_b16 a[252:253], v15 offset:49152
    ds_read_b64_tr_b16 a[254:255], v15 offset:53248
    v_mfma_f32_16x16x32_bf16 a[16:19], v[36:39], v[248:251], a[16:19]
    s_waitcnt lgkmcnt(12)
    v_mfma_f32_16x16x32_bf16 a[20:23], v[40:43], v[232:235], a[20:23]
    v_mfma_f32_16x16x32_bf16 a[24:27], v[40:43], v[236:239], a[24:27]
    v_mfma_f32_16x16x32_bf16 a[28:31], v[40:43], v[240:243], a[28:31]
    v_mfma_f32_16x16x32_bf16 a[32:35], v[40:43], v[244:247], a[32:35]
    v_min3_f32 v1, v52, v56, v60
    v_max3_f32 v2, v52, v56, v60
    v_min3_f32 v1, v1, v64, v68
    v_max3_f32 v2, v2, v64, v68
    v_mfma_f32_16x16x32_bf16 a[36:39], v[40:43], v[248:251], a[36:39]
    s_waitcnt lgkmcnt(10)
L_t3a0:
    v_cmp_gt_f32 vcc, 0x39800000, v1
    s_nop 1
    s_mov_b64 s[42:43], vcc
    v_cmp_lt_f32 vcc, 0x4f800000, v2
    s_nop 1
    s_or_b64 s[42:43], s[42:43], vcc
    s_cselect_b32 s42, 1, 0
    v_mov_b32 v1, s42
    ds_write_b32 v31, v1 offset:0
    s_mov_b32 s18, 262144
    s_mov_b32 s22, 262144
    v_mfma_f32_16x16x32_bf16 a[40:43], v[44:47], v[232:235], a[40:43]
    v_mfma_f32_16x16x32_bf16 a[44:47], v[44:47], v[236:239], a[44:47]
    v_mfma_f32_16x16x32_bf16 a[48:51], v[44:47], v[240:243], a[48:51]
    v_mfma_f32_16x16x32_bf16 a[52:55], v[44:47], v[244:247], a[52:55]
    s_waitcnt vmcnt(0) lgkmcnt(0)
    s_barrier
    v_mfma_f32_16x16x32_bf16 a[56:59], v[44:47], v[248:251], a[56:59]
    ds_read_b32 v172, v254 offset:0
    v_mfma_f32_16x16x32_bf16 a[60:63], v[48:51], v[232:235], a[60:63]
    s_mov_b32 s98, 1
    s_mov_b32 s10, 163840
    s_mov_b32 s14, s53
    s_lshl_b32 s40, s62, 7
    s_add_u32 s40, s40, s52
    s_lshl_b32 s41, s62, 19
    s_lshl_b32 s63, s98, 8
    s_add_u32 s41, s41, s63
    s_add_u32 m0, s51, 0
    s_add_u32 s46, s40, 0
    buffer_load_dwordx4 v26, s[8:11], s46 offen offset:0 lds
    v_mfma_f32_16x16x32_bf16 a[64:67], v[48:51], v[236:239], a[64:67]
    v_mfma_f32_16x16x32_bf16 a[68:71], v[48:51], v[240:243], a[68:71]
    s_add_u32 s46, s40, 7168
    buffer_load_dwordx4 v27, s[8:11], s46 offen offset:1024 lds
    v_mfma_f32_16x16x32_bf16 a[72:75], v[48:51], v[244:247], a[72:75]
    s_add_u32 s46, s40, 14336
    buffer_load_dwordx4 v26, s[8:11], s46 offen offset:2048 lds
    v_mfma_f32_16x16x32_bf16 a[76:79], v[48:51], v[248:251], a[76:79]
    v_mfma_f32_16x16x32_bf16 a[80:83], a[240:243], v[232:235], a[80:83]
    s_add_u32 s46, s40, 21504
    buffer_load_dwordx4 v27, s[8:11], s46 offen offset:3072 lds
    v_mfma_f32_16x16x32_bf16 a[84:87], a[240:243], v[236:239], a[84:87]
    v_mfma_f32_16x16x32_bf16 a[88:91], a[240:243], v[240:243], a[88:91]
    s_add_u32 m0, s51, 4096
    s_add_u32 s46, s40, 32768
    buffer_load_dwordx4 v26, s[8:11], s46 offen offset:0 lds
    v_mfma_f32_16x16x32_bf16 a[92:95], a[240:243], v[244:247], a[92:95]
    s_add_u32 s63, s40, 128
    s_andn2_b32 s40, s63, 1024
    s_add_u32 m0, s50, 0
    s_add_u32 s42, s41, 0
    buffer_load_dwordx4 v28, s[12:15], s42 offen offset:0 lds
    v_mfma_f32_16x16x32_bf16 a[96:99], a[240:243], v[248:251], a[96:99]
    v_mfma_f32_16x16x32_bf16 a[100:103], a[244:247], v[232:235], a[100:103]
    s_add_u32 s42, s41, 31744
    buffer_load_dwordx4 v28, s[12:15], s42 offen offset:1024 lds
    v_mfma_f32_16x16x32_bf16 a[104:107], a[244:247], v[236:239], a[104:107]
    v_mfma_f32_16x16x32_bf16 a[108:111], a[244:247], v[240:243], a[108:111]
    s_add_u32 s42, s41, 63488
    buffer_load_dwordx4 v28, s[12:15], s42 offen offset:2048 lds
    v_mfma_f32_16x16x32_bf16 a[112:115], a[244:247], v[244:247], a[112:115]
    s_add_u32 s42, s41, 95232
    buffer_load_dwordx4 v28, s[12:15], s42 offen offset:3072 lds
    v_mfma_f32_16x16x32_bf16 a[116:119], a[244:247], v[248:251], a[116:119]
    v_mfma_f32_16x16x32_bf16 a[120:123], a[248:251], v[232:235], a[120:123]
    s_add_u32 s41, s41, 262144
    s_and_b32 s41, s41, 0x3fffff
    s_add_u32 m0, s50, 8192
    s_add_u32 s42, s41, 0
    buffer_load_dwordx4 v28, s[12:15], s42 offen offset:0 lds
    v_mfma_f32_16x16x32_bf16 a[124:127], a[248:251], v[236:239], a[124:127]
    v_mfma_f32_16x16x32_bf16 a[128:131], a[248:251], v[240:243], a[128:131]
    s_add_u32 s42, s41, 31744
    buffer_load_dwordx4 v28, s[12:15], s42 offen offset:1024 lds
    v_mfma_f32_16x16x32_bf16 a[132:135], a[248:251], v[244:247], a[132:135]
    s_add_u32 s42, s41, 63488
    buffer_load_dwordx4 v28, s[12:15], s42 offen offset:2048 lds
    v_mfma_f32_16x16x32_bf16 a[136:139], a[248:251], v[248:251], a[136:139]
    v_mfma_f32_16x16x32_bf16 a[140:143], a[252:255], v[232:235], a[140:143]
    s_add_u32 s42, s41, 95232
    buffer_load_dwordx4 v28, s[12:15], s42 offen offset:3072 lds
    v_mfma_f32_16x16x32_bf16 a[144:147], a[252:255], v[236:239], a[144:147]
    v_mfma_f32_16x16x32_bf16 a[148:151], a[252:255], v[240:243], a[148:151]
    v_mfma_f32_16x16x32_bf16 a[152:155], a[252:255], v[244:247], a[152:155]
    v_mfma_f32_16x16x32_bf16 a[156:159], a[252:255], v[248:251], a[156:159]
    s_add_u32 s41, s41, 262144
    s_and_b32 s41, s41, 0x3fffff
    s_waitcnt lgkmcnt(0)
    v_cmp_lt_u32 vcc, s61, v172
    s_nop 4
    s_cbranch_vccnz L_fallback
    s_mov_b32 s35, 1
    s_mov_b32 s61, 0
    s_mov_b32 s101, 3
    v_rcp_f32 v52, v52
    v_rcp_f32 v56, v56
    v_rcp_f32 v60, v60
    v_rcp_f32 v64, v64
    v_rcp_f32 v68, v68
    v_accvgpr_read_b32 v172, a0
    v_accvgpr_read_b32 v173, a1
    v_accvgpr_read_b32 v174, a2
    v_accvgpr_read_b32 v175, a3
    v_accvgpr_read_b32 v176, a20
    v_accvgpr_read_b32 v177, a21
    v_accvgpr_read_b32 v178, a22
    v_accvgpr_read_b32 v179, a23
    v_pk_mul_f32 v[172:173], v[172:173], v[52:53] op_sel_hi:[1,0]
    v_pk_mul_f32 v[174:175], v[174:175], v[52:53] op_sel_hi:[1,0]
    v_pk_mul_f32 v[176:177], v[176:177], v[52:53] op_sel_hi:[1,0]
    v_pk_mul_f32 v[178:179], v[178:179], v[52:53] op_sel_hi:[1,0]
    v_cvt_pk_bf16_f32 v92, v172, v173
    v_cvt_pk_bf16_f32 v93, v174, v175
    v_cvt_pk_bf16_f32 v94, v176, v177
    v_cvt_pk_bf16_f32 v95, v178, v179
    v_accvgpr_read_b32 v180, a4
    v_accvgpr_read_b32 v181, a5
    v_accvgpr_read_b32 v182, a6
    v_accvgpr_read_b32 v183, a7
    v_accvgpr_read_b32 v184, a24
    v_accvgpr_read_b32 v185, a25
    v_accvgpr_read_b32 v186, a26
    v_accvgpr_read_b32 v187, a27
    v_pk_mul_f32 v[180:181], v[180:181], v[56:57] op_sel_hi:[1,0]
    v_pk_mul_f32 v[182:183], v[182:183], v[56:57] op_sel_hi:[1,0]
    v_pk_mul_f32 v[184:185], v[184:185], v[56:57] op_sel_hi:[1,0]
    v_pk_mul_f32 v[186:187], v[186:187], v[56:57] op_sel_hi:[1,0]
    v_cvt_pk_bf16_f32 v96, v180, v181
    v_cvt_pk_bf16_f32 v97, v182, v183
    v_cvt_pk_bf16_f32 v98, v184, v185
    v_cvt_pk_bf16_f32 v99, v186, v187
    v_accvgpr_read_b32 v188, a8
    v_accvgpr_read_b32 v189, a9
    v_accvgpr_read_b32 v190, a10
    v_accvgpr_read_b32 v191, a11
    v_accvgpr_read_b32 v192, a28
    v_accvgpr_read_b32 v193, a29
    v_accvgpr_read_b32 v194, a30
    v_accvgpr_read_b32 v195, a31
    v_pk_mul_f32 v[188:189], v[188:189], v[60:61] op_sel_hi:[1,0]
    v_pk_mul_f32 v[190:191], v[190:191], v[60:61] op_sel_hi:[1,0]
    v_pk_mul_f32 v[192:193], v[192:193], v[60:61] op_sel_hi:[1,0]
    v_pk_mul_f32 v[194:195], v[194:195], v[60:61] op_sel_hi:[1,0]
    v_cvt_pk_bf16_f32 v100, v188, v189
    v_cvt_pk_bf16_f32 v101, v190, v191
    v_cvt_pk_bf16_f32 v102, v192, v193
    v_cvt_pk_bf16_f32 v103, v194, v195
    v_accvgpr_read_b32 v196, a12
    v_accvgpr_read_b32 v197, a13
    v_accvgpr_read_b32 v198, a14
    v_accvgpr_read_b32 v199, a15
    v_accvgpr_read_b32 v200, a32
    v_accvgpr_read_b32 v201, a33
    v_accvgpr_read_b32 v202, a34
    v_accvgpr_read_b32 v203, a35
    v_pk_mul_f32 v[196:197], v[196:197], v[64:65] op_sel_hi:[1,0]
    v_pk_mul_f32 v[198:199], v[198:199], v[64:65] op_sel_hi:[1,0]
    v_pk_mul_f32 v[200:201], v[200:201], v[64:65] op_sel_hi:[1,0]
    v_pk_mul_f32 v[202:203], v[202:203], v[64:65] op_sel_hi:[1,0]
    v_cvt_pk_bf16_f32 v104, v196, v197
    v_cvt_pk_bf16_f32 v105, v198, v199
    v_cvt_pk_bf16_f32 v106, v200, v201
    v_cvt_pk_bf16_f32 v107, v202, v203
    v_accvgpr_read_b32 v172, a16
    v_accvgpr_read_b32 v173, a17
    v_accvgpr_read_b32 v174, a18
    v_accvgpr_read_b32 v175, a19
    v_accvgpr_read_b32 v176, a36
    v_accvgpr_read_b32 v177, a37
    v_accvgpr_read_b32 v178, a38
    v_accvgpr_read_b32 v179, a39
    v_pk_mul_f32 v[172:173], v[172:173], v[68:69] op_sel_hi:[1,0]
    v_pk_mul_f32 v[174:175], v[174:175], v[68:69] op_sel_hi:[1,0]
    v_pk_mul_f32 v[176:177], v[176:177], v[68:69] op_sel_hi:[1,0]
    v_pk_mul_f32 v[178:179], v[178:179], v[68:69] op_sel_hi:[1,0]
    v_cvt_pk_bf16_f32 v108, v172, v173
    v_cvt_pk_bf16_f32 v109, v174, v175
    v_cvt_pk_bf16_f32 v110, v176, v177
    v_cvt_pk_bf16_f32 v111, v178, v179
    v_accvgpr_read_b32 v180, a40
    v_accvgpr_read_b32 v181, a41
    v_accvgpr_read_b32 v182, a42
    v_accvgpr_read_b32 v183, a43
    v_accvgpr_read_b32 v184, a60
    v_accvgpr_read_b32 v185, a61
    v_accvgpr_read_b32 v186, a62
    v_accvgpr_read_b32 v187, a63
    v_pk_mul_f32 v[180:181], v[180:181], v[52:53] op_sel_hi:[1,0]
    v_pk_mul_f32 v[182:183], v[182:183], v[52:53] op_sel_hi:[1,0]
    v_pk_mul_f32 v[184:185], v[184:185], v[52:53] op_sel_hi:[1,0]
    v_pk_mul_f32 v[186:187], v[186:187], v[52:53] op_sel_hi:[1,0]
    v_cvt_pk_bf16_f32 v112, v180, v181
    v_cvt_pk_bf16_f32 v113, v182, v183
    v_cvt_pk_bf16_f32 v114, v184, v185
    v_cvt_pk_bf16_f32 v115, v186, v187
    v_accvgpr_read_b32 v188, a44
    v_accvgpr_read_b32 v189, a45
    v_accvgpr_read_b32 v190, a46
    v_accvgpr_read_b32 v191, a47
    v_accvgpr_read_b32 v192, a64
    v_accvgpr_read_b32 v193, a65
    v_accvgpr_read_b32 v194, a66
    v_accvgpr_read_b32 v195, a67
    v_pk_mul_f32 v[188:189], v[188:189], v[56:57] op_sel_hi:[1,0]
    v_pk_mul_f32 v[190:191], v[190:191], v[56:57] op_sel_hi:[1,0]
    v_pk_mul_f32 v[192:193], v[192:193], v[56:57] op_sel_hi:[1,0]
    v_pk_mul_f32 v[194:195], v[194:195], v[56:57] op_sel_hi:[1,0]
    v_cvt_pk_bf16_f32 v116, v188, v189
    v_cvt_pk_bf16_f32 v117, v190, v191
    v_cvt_pk_bf16_f32 v118, v192, v193
    v_cvt_pk_bf16_f32 v119, v194, v195
    v_accvgpr_read_b32 v196, a48
    v_accvgpr_read_b32 v197, a49
    v_accvgpr_read_b32 v198, a50
    v_accvgpr_read_b32 v199, a51
    v_accvgpr_read_b32 v200, a68
    v_accvgpr_read_b32 v201, a69
    v_accvgpr_read_b32 v202, a70
    v_accvgpr_read_b32 v203, a71
    v_pk_mul_f32 v[196:197], v[196:197], v[60:61] op_sel_hi:[1,0]
    v_pk_mul_f32 v[198:199], v[198:199], v[60:61] op_sel_hi:[1,0]
    v_pk_mul_f32 v[200:201], v[200:201], v[60:61] op_sel_hi:[1,0]
    v_pk_mul_f32 v[202:203], v[202:203], v[60:61] op_sel_hi:[1,0]
    v_cvt_pk_bf16_f32 v120, v196, v197
    v_cvt_pk_bf16_f32 v121, v198, v199
    v_cvt_pk_bf16_f32 v122, v200, v201
    v_cvt_pk_bf16_f32 v123, v202, v203
    v_accvgpr_read_b32 v172, a52
    v_accvgpr_read_b32 v173, a53
    v_accvgpr_read_b32 v174, a54
    v_accvgpr_read_b32 v175, a55
    v_accvgpr_read_b32 v176, a72
    v_accvgpr_read_b32 v177, a73
    v_accvgpr_read_b32 v178, a74
    v_accvgpr_read_b32 v179, a75
    v_pk_mul_f32 v[172:173], v[172:173], v[64:65] op_sel_hi:[1,0]
    v_pk_mul_f32 v[174:175], v[174:175], v[64:65] op_sel_hi:[1,0]
    v_pk_mul_f32 v[176:177], v[176:177], v[64:65] op_sel_hi:[1,0]
    v_pk_mul_f32 v[178:179], v[178:179], v[64:65] op_sel_hi:[1,0]
    v_cvt_pk_bf16_f32 v124, v172, v173
    v_cvt_pk_bf16_f32 v125, v174, v175
    v_cvt_pk_bf16_f32 v126, v176, v177
    v_cvt_pk_bf16_f32 v127, v178, v179
    v_accvgpr_read_b32 v180, a56
    v_accvgpr_read_b32 v181, a57
    v_accvgpr_read_b32 v182, a58
    v_accvgpr_read_b32 v183, a59
    v_accvgpr_read_b32 v184, a76
    v_accvgpr_read_b32 v185, a77
    v_accvgpr_read_b32 v186, a78
    v_accvgpr_read_b32 v187, a79
    v_pk_mul_f32 v[180:181], v[180:181], v[68:69] op_sel_hi:[1,0]
    v_pk_mul_f32 v[182:183], v[182:183], v[68:69] op_sel_hi:[1,0]
    v_pk_mul_f32 v[184:185], v[184:185], v[68:69] op_sel_hi:[1,0]
    v_pk_mul_f32 v[186:187], v[186:187], v[68:69] op_sel_hi:[1,0]
    v_cvt_pk_bf16_f32 v128, v180, v181
    v_cvt_pk_bf16_f32 v129, v182, v183
    v_cvt_pk_bf16_f32 v130, v184, v185
    v_cvt_pk_bf16_f32 v131, v186, v187
    v_accvgpr_read_b32 v188, a80
    v_accvgpr_read_b32 v189, a81
    v_accvgpr_read_b32 v190, a82
    v_accvgpr_read_b32 v191, a83
    v_accvgpr_read_b32 v192, a100
    v_accvgpr_read_b32 v193, a101
    v_accvgpr_read_b32 v194, a102
    v_accvgpr_read_b32 v195, a103
    v_pk_mul_f32 v[188:189], v[188:189], v[52:53] op_sel_hi:[1,0]
    v_pk_mul_f32 v[190:191], v[190:191], v[52:53] op_sel_hi:[1,0]
    v_pk_mul_f32 v[192:193], v[192:193], v[52:53] op_sel_hi:[1,0]
    v_pk_mul_f32 v[194:195], v[194:195], v[52:53] op_sel_hi:[1,0]
    v_cvt_pk_bf16_f32 v132, v188, v189
    v_cvt_pk_bf16_f32 v133, v190, v191
    v_cvt_pk_bf16_f32 v134, v192, v193
    v_cvt_pk_bf16_f32 v135, v194, v195
    v_accvgpr_read_b32 v196, a84
    v_accvgpr_read_b32 v197, a85
    v_accvgpr_read_b32 v198, a86
    v_accvgpr_read_b32 v199, a87
    v_accvgpr_read_b32 v200, a104
    v_accvgpr_read_b32 v201, a105
    v_accvgpr_read_b32 v202, a106
    v_accvgpr_read_b32 v203, a107
    v_pk_mul_f32 v[196:197], v[196:197], v[56:57] op_sel_hi:[1,0]
    v_pk_mul_f32 v[198:199], v[198:199], v[56:57] op_sel_hi:[1,0]
    v_pk_mul_f32 v[200:201], v[200:201], v[56:57] op_sel_hi:[1,0]
    v_pk_mul_f32 v[202:203], v[202:203], v[56:57] op_sel_hi:[1,0]
    v_cvt_pk_bf16_f32 v136, v196, v197
    v_cvt_pk_bf16_f32 v137, v198, v199
    v_cvt_pk_bf16_f32 v138, v200, v201
    v_cvt_pk_bf16_f32 v139, v202, v203
    v_accvgpr_read_b32 v172, a88
    v_accvgpr_read_b32 v173, a89
    v_accvgpr_read_b32 v174, a90
    v_accvgpr_read_b32 v175, a91
    v_accvgpr_read_b32 v176, a108
    v_accvgpr_read_b32 v177, a109
    v_accvgpr_read_b32 v178, a110
    v_accvgpr_read_b32 v179, a111
    v_pk_mul_f32 v[172:173], v[172:173], v[60:61] op_sel_hi:[1,0]
    v_pk_mul_f32 v[174:175], v[174:175], v[60:61] op_sel_hi:[1,0]
    v_pk_mul_f32 v[176:177], v[176:177], v[60:61] op_sel_hi:[1,0]
    v_pk_mul_f32 v[178:179], v[178:179], v[60:61] op_sel_hi:[1,0]
    v_cvt_pk_bf16_f32 v140, v172, v173
    v_cvt_pk_bf16_f32 v141, v174, v175
    v_cvt_pk_bf16_f32 v142, v176, v177
    v_cvt_pk_bf16_f32 v143, v178, v179
    v_accvgpr_read_b32 v180, a92
    v_accvgpr_read_b32 v181, a93
    v_accvgpr_read_b32 v182, a94
    v_accvgpr_read_b32 v183, a95
    v_accvgpr_read_b32 v184, a112
    v_accvgpr_read_b32 v185, a113
    v_accvgpr_read_b32 v186, a114
    v_accvgpr_read_b32 v187, a115
    v_pk_mul_f32 v[180:181], v[180:181], v[64:65] op_sel_hi:[1,0]
    v_pk_mul_f32 v[182:183], v[182:183], v[64:65] op_sel_hi:[1,0]
    v_pk_mul_f32 v[184:185], v[184:185], v[64:65] op_sel_hi:[1,0]
    v_pk_mul_f32 v[186:187], v[186:187], v[64:65] op_sel_hi:[1,0]
    v_cvt_pk_bf16_f32 v144, v180, v181
    v_cvt_pk_bf16_f32 v145, v182, v183
    v_cvt_pk_bf16_f32 v146, v184, v185
    v_cvt_pk_bf16_f32 v147, v186, v187
    v_accvgpr_read_b32 v188, a96
    v_accvgpr_read_b32 v189, a97
    v_accvgpr_read_b32 v190, a98
    v_accvgpr_read_b32 v191, a99
    v_accvgpr_read_b32 v192, a116
    v_accvgpr_read_b32 v193, a117
    v_accvgpr_read_b32 v194, a118
    v_accvgpr_read_b32 v195, a119
    v_pk_mul_f32 v[188:189], v[188:189], v[68:69] op_sel_hi:[1,0]
    v_pk_mul_f32 v[190:191], v[190:191], v[68:69] op_sel_hi:[1,0]
    v_pk_mul_f32 v[192:193], v[192:193], v[68:69] op_sel_hi:[1,0]
    v_pk_mul_f32 v[194:195], v[194:195], v[68:69] op_sel_hi:[1,0]
    v_cvt_pk_bf16_f32 v148, v188, v189
    v_cvt_pk_bf16_f32 v149, v190, v191
    v_cvt_pk_bf16_f32 v150, v192, v193
    v_cvt_pk_bf16_f32 v151, v194, v195
    v_accvgpr_read_b32 v196, a120
    v_accvgpr_read_b32 v197, a121
    v_accvgpr_read_b32 v198, a122
    v_accvgpr_read_b32 v199, a123
    v_accvgpr_read_b32 v200, a140
    v_accvgpr_read_b32 v201, a141
    v_accvgpr_read_b32 v202, a142
    v_accvgpr_read_b32 v203, a143
    v_pk_mul_f32 v[196:197], v[196:197], v[52:53] op_sel_hi:[1,0]
    v_pk_mul_f32 v[198:199], v[198:199], v[52:53] op_sel_hi:[1,0]
    v_pk_mul_f32 v[200:201], v[200:201], v[52:53] op_sel_hi:[1,0]
    v_pk_mul_f32 v[202:203], v[202:203], v[52:53] op_sel_hi:[1,0]
    v_cvt_pk_bf16_f32 v152, v196, v197
    v_cvt_pk_bf16_f32 v153, v198, v199
    v_cvt_pk_bf16_f32 v154, v200, v201
    v_cvt_pk_bf16_f32 v155, v202, v203
    v_accvgpr_read_b32 v172, a124
    v_accvgpr_read_b32 v173, a125
    v_accvgpr_read_b32 v174, a126
    v_accvgpr_read_b32 v175, a127
    v_accvgpr_read_b32 v176, a144
    v_accvgpr_read_b32 v177, a145
    v_accvgpr_read_b32 v178, a146
    v_accvgpr_read_b32 v179, a147
    v_pk_mul_f32 v[172:173], v[172:173], v[56:57] op_sel_hi:[1,0]
    v_pk_mul_f32 v[174:175], v[174:175], v[56:57] op_sel_hi:[1,0]
    v_pk_mul_f32 v[176:177], v[176:177], v[56:57] op_sel_hi:[1,0]
    v_pk_mul_f32 v[178:179], v[178:179], v[56:57] op_sel_hi:[1,0]
    v_cvt_pk_bf16_f32 v156, v172, v173
    v_cvt_pk_bf16_f32 v157, v174, v175
    v_cvt_pk_bf16_f32 v158, v176, v177
    v_cvt_pk_bf16_f32 v159, v178, v179
    v_accvgpr_read_b32 v180, a128
    v_accvgpr_read_b32 v181, a129
    v_accvgpr_read_b32 v182, a130
    v_accvgpr_read_b32 v183, a131
    v_accvgpr_read_b32 v184, a148
    v_accvgpr_read_b32 v185, a149
    v_accvgpr_read_b32 v186, a150
    v_accvgpr_read_b32 v187, a151
    v_pk_mul_f32 v[180:181], v[180:181], v[60:61] op_sel_hi:[1,0]
    v_pk_mul_f32 v[182:183], v[182:183], v[60:61] op_sel_hi:[1,0]
    v_pk_mul_f32 v[184:185], v[184:185], v[60:61] op_sel_hi:[1,0]
    v_pk_mul_f32 v[186:187], v[186:187], v[60:61] op_sel_hi:[1,0]
    v_cvt_pk_bf16_f32 v160, v180, v181
    v_cvt_pk_bf16_f32 v161, v182, v183
    v_cvt_pk_bf16_f32 v162, v184, v185
    v_cvt_pk_bf16_f32 v163, v186, v187
    v_accvgpr_read_b32 v188, a132
    v_accvgpr_read_b32 v189, a133
    v_accvgpr_read_b32 v190, a134
    v_accvgpr_read_b32 v191, a135
    v_accvgpr_read_b32 v192, a152
    v_accvgpr_read_b32 v193, a153
    v_accvgpr_read_b32 v194, a154
    v_accvgpr_read_b32 v195, a155
    v_pk_mul_f32 v[188:189], v[188:189], v[64:65] op_sel_hi:[1,0]
    v_pk_mul_f32 v[190:191], v[190:191], v[64:65] op_sel_hi:[1,0]
    v_pk_mul_f32 v[192:193], v[192:193], v[64:65] op_sel_hi:[1,0]
    v_pk_mul_f32 v[194:195], v[194:195], v[64:65] op_sel_hi:[1,0]
    v_cvt_pk_bf16_f32 v164, v188, v189
    v_cvt_pk_bf16_f32 v165, v190, v191
    v_cvt_pk_bf16_f32 v166, v192, v193
    v_cvt_pk_bf16_f32 v167, v194, v195
    v_accvgpr_read_b32 v196, a136
    v_accvgpr_read_b32 v197, a137
    v_accvgpr_read_b32 v198, a138
    v_accvgpr_read_b32 v199, a139
    v_accvgpr_read_b32 v200, a156
    v_accvgpr_read_b32 v201, a157
    v_accvgpr_read_b32 v202, a158
    v_accvgpr_read_b32 v203, a159
    v_pk_mul_f32 v[196:197], v[196:197], v[68:69] op_sel_hi:[1,0]
    v_pk_mul_f32 v[198:199], v[198:199], v[68:69] op_sel_hi:[1,0]
    v_pk_mul_f32 v[200:201], v[200:201], v[68:69] op_sel_hi:[1,0]
    v_pk_mul_f32 v[202:203], v[202:203], v[68:69] op_sel_hi:[1,0]
    v_cvt_pk_bf16_f32 v168, v196, v197
    v_cvt_pk_bf16_f32 v169, v198, v199
    v_cvt_pk_bf16_f32 v170, v200, v201
    v_cvt_pk_bf16_f32 v171, v202, v203
    v_accvgpr_write_b32 a160, v92
    v_accvgpr_write_b32 a161, v93
    v_accvgpr_write_b32 a162, v94
    v_accvgpr_write_b32 a163, v95
    v_accvgpr_write_b32 a164, v96
    v_accvgpr_write_b32 a165, v97
    v_accvgpr_write_b32 a166, v98
    v_accvgpr_write_b32 a167, v99
    v_accvgpr_write_b32 a168, v100
    v_accvgpr_write_b32 a169, v101
    v_accvgpr_write_b32 a170, v102
    v_accvgpr_write_b32 a171, v103
    v_accvgpr_write_b32 a172, v104
    v_accvgpr_write_b32 a173, v105
    v_accvgpr_write_b32 a174, v106
    v_accvgpr_write_b32 a175, v107
    v_accvgpr_write_b32 a176, v108
    v_accvgpr_write_b32 a177, v109
    v_accvgpr_write_b32 a178, v110
    v_accvgpr_write_b32 a179, v111
    v_accvgpr_write_b32 a180, v112
    v_accvgpr_write_b32 a181, v113
    v_accvgpr_write_b32 a182, v114
    v_accvgpr_write_b32 a183, v115
    v_accvgpr_write_b32 a184, v116
    v_accvgpr_write_b32 a185, v117
    v_accvgpr_write_b32 a186, v118
    v_accvgpr_write_b32 a187, v119
    v_accvgpr_write_b32 a188, v120
    v_accvgpr_write_b32 a189, v121
    v_accvgpr_write_b32 a190, v122
    v_accvgpr_write_b32 a191, v123
    v_accvgpr_write_b32 a192, v124
    v_accvgpr_write_b32 a193, v125
    v_accvgpr_write_b32 a194, v126
    v_accvgpr_write_b32 a195, v127
    v_accvgpr_write_b32 a196, v128
    v_accvgpr_write_b32 a197, v129
    v_accvgpr_write_b32 a198, v130
    v_accvgpr_write_b32 a199, v131
    v_accvgpr_write_b32 a200, v132
    v_accvgpr_write_b32 a201, v133
    v_accvgpr_write_b32 a202, v134
    v_accvgpr_write_b32 a203, v135
    v_accvgpr_write_b32 a204, v136
    v_accvgpr_write_b32 a205, v137
    v_accvgpr_write_b32 a206, v138
    v_accvgpr_write_b32 a207, v139
    v_accvgpr_write_b32 a208, v140
    v_accvgpr_write_b32 a209, v141
    v_accvgpr_write_b32 a210, v142
    v_accvgpr_write_b32 a211, v143
    v_accvgpr_write_b32 a212, v144
    v_accvgpr_write_b32 a213, v145
    v_accvgpr_write_b32 a214, v146
    v_accvgpr_write_b32 a215, v147
    v_accvgpr_write_b32 a216, v148
    v_accvgpr_write_b32 a217, v149
    v_accvgpr_write_b32 a218, v150
    v_accvgpr_write_b32 a219, v151
    v_accvgpr_write_b32 a220, v152
    v_accvgpr_write_b32 a221, v153
    v_accvgpr_write_b32 a222, v154
    v_accvgpr_write_b32 a223, v155
    v_accvgpr_write_b32 a224, v156
    v_accvgpr_write_b32 a225, v157
    v_accvgpr_write_b32 a226, v158
    v_accvgpr_write_b32 a227, v159
    v_accvgpr_write_b32 a228, v160
    v_accvgpr_write_b32 a229, v161
    v_accvgpr_write_b32 a230, v162
    v_accvgpr_write_b32 a231, v163
    v_accvgpr_write_b32 a232, v164
    v_accvgpr_write_b32 a233, v165
    v_accvgpr_write_b32 a234, v166
    v_accvgpr_write_b32 a235, v167
    v_accvgpr_write_b32 a236, v168
    v_accvgpr_write_b32 a237, v169
    v_accvgpr_write_b32 a238, v170
    v_accvgpr_write_b32 a239, v171
    s_branch L_q
L_atail1:
    v_cvt_pk_bf16_f32 v250, v208, v209
    v_exp_f32 v210, v210
    v_exp_f32 v211, v211
    s_nop 0
    v_cvt_pk_bf16_f32 v251, v210, v211
    s_waitcnt lgkmcnt(3)
    ds_read_b64_tr_b16 v[36:37], v8 offset:49152
    ds_read_b64_tr_b16 v[38:39], v8 offset:53248
    s_waitcnt lgkmcnt(3)
    ds_read_b64_tr_b16 v[40:41], v9 offset:49152
    ds_read_b64_tr_b16 v[42:43], v9 offset:53248
    ds_read_b64_tr_b16 v[44:45], v10 offset:49152
    ds_read_b64_tr_b16 v[46:47], v10 offset:53248
    s_waitcnt lgkmcnt(6)
    ds_read_b64_tr_b16 v[48:49], v11 offset:49152
    ds_read_b64_tr_b16 v[50:51], v11 offset:53248
    ds_read_b64_tr_b16 a[240:241], v12 offset:49152
    ds_read_b64_tr_b16 a[242:243], v12 offset:53248
    v_mfma_f32_16x16x32_bf16 v[52:55], v[32:35], v[232:235], v[52:55]
    ds_read_b64_tr_b16 a[244:245], v13 offset:49152
    ds_read_b64_tr_b16 a[246:247], v13 offset:53248
    v_mfma_f32_16x16x32_bf16 v[56:59], v[32:35], v[236:239], v[56:59]
    v_mfma_f32_16x16x32_bf16 v[60:63], v[32:35], v[240:243], v[60:63]
    v_mfma_f32_16x16x32_bf16 v[64:67], v[32:35], v[244:247], v[64:67]
    v_mfma_f32_16x16x32_bf16 v[68:71], v[32:35], v[248:251], v[68:71]
    s_waitcnt lgkmcnt(10)
    ds_read_b64_tr_b16 a[248:249], v14 offset:49152
    ds_read_b64_tr_b16 a[250:251], v14 offset:53248
    v_mfma_f32_16x16x32_bf16 a[0:3], v[36:39], v[232:235], a[0:3]
    v_mfma_f32_16x16x32_bf16 a[4:7], v[36:39], v[236:239], a[4:7]
    v_mfma_f32_16x16x32_bf16 a[8:11], v[36:39], v[240:243], a[8:11]
    v_mfma_f32_16x16x32_bf16 a[12:15], v[36:39], v[244:247], a[12:15]
    ds_read_b64_tr_b16 a[252:253], v15 offset:49152
    ds_read_b64_tr_b16 a[254:255], v15 offset:53248
    v_mfma_f32_16x16x32_bf16 a[16:19], v[36:39], v[248:251], a[16:19]
    s_waitcnt lgkmcnt(12)
    v_mfma_f32_16x16x32_bf16 a[20:23], v[40:43], v[232:235], a[20:23]
    v_mfma_f32_16x16x32_bf16 a[24:27], v[40:43], v[236:239], a[24:27]
    v_mfma_f32_16x16x32_bf16 a[28:31], v[40:43], v[240:243], a[28:31]
    v_mfma_f32_16x16x32_bf16 a[32:35], v[40:43], v[244:247], a[32:35]
    v_min3_f32 v1, v52, v56, v60
    v_max3_f32 v2, v52, v56, v60
    v_min3_f32 v1, v1, v64, v68
    v_max3_f32 v2, v2, v64, v68
    v_mfma_f32_16x16x32_bf16 a[36:39], v[40:43], v[248:251], a[36:39]
    s_waitcnt lgkmcnt(10)
L_t3a1:
    v_cmp_gt_f32 vcc, 0x39800000, v1
    s_nop 1
    s_mov_b64 s[42:43], vcc
    v_cmp_lt_f32 vcc, 0x4f800000, v2
    s_nop 1
    s_or_b64 s[42:43], s[42:43], vcc
    s_cselect_b32 s42, 1, 0
    v_mov_b32 v1, s42
    ds_write_b32 v31, v1 offset:0
    s_mov_b32 s18, 262144
    s_mov_b32 s22, 262144
    v_mfma_f32_16x16x32_bf16 a[40:43], v[44:47], v[232:235], a[40:43]
    v_mfma_f32_16x16x32_bf16 a[44:47], v[44:47], v[236:239], a[44:47]
    v_mfma_f32_16x16x32_bf16 a[48:51], v[44:47], v[240:243], a[48:51]
    v_mfma_f32_16x16x32_bf16 a[52:55], v[44:47], v[244:247], a[52:55]
    s_waitcnt vmcnt(0) lgkmcnt(0)
    s_barrier
    v_mfma_f32_16x16x32_bf16 a[56:59], v[44:47], v[248:251], a[56:59]
    ds_read_b32 v172, v254 offset:0
    v_mfma_f32_16x16x32_bf16 a[60:63], v[48:51], v[232:235], a[60:63]
    s_add_u32 m0, s56, 122880
    s_add_u32 s42, s57, 0
    buffer_load_dwordx4 v29, s[24:27], s42 offen offset:0 lds
    v_mfma_f32_16x16x32_bf16 a[64:67], v[48:51], v[236:239], a[64:67]
    v_mfma_f32_16x16x32_bf16 a[68:71], v[48:51], v[240:243], a[68:71]
    v_mfma_f32_16x16x32_bf16 a[72:75], v[48:51], v[244:247], a[72:75]
    s_add_u32 s42, s57, 7168
    buffer_load_dwordx4 v29, s[24:27], s42 offen offset:1024 lds
    v_mfma_f32_16x16x32_bf16 a[76:79], v[48:51], v[248:251], a[76:79]
    v_mfma_f32_16x16x32_bf16 a[80:83], a[240:243], v[232:235], a[80:83]
    v_mfma_f32_16x16x32_bf16 a[84:87], a[240:243], v[236:239], a[84:87]
    s_add_u32 s42, s57, 14336
    buffer_load_dwordx4 v29, s[24:27], s42 offen offset:2048 lds
    v_mfma_f32_16x16x32_bf16 a[88:91], a[240:243], v[240:243], a[88:91]
    v_mfma_f32_16x16x32_bf16 a[92:95], a[240:243], v[244:247], a[92:95]
    v_mfma_f32_16x16x32_bf16 a[96:99], a[240:243], v[248:251], a[96:99]
    v_mfma_f32_16x16x32_bf16 a[100:103], a[244:247], v[232:235], a[100:103]
    s_add_u32 s42, s57, 21504
    buffer_load_dwordx4 v29, s[24:27], s42 offen offset:3072 lds
    v_mfma_f32_16x16x32_bf16 a[104:107], a[244:247], v[236:239], a[104:107]
    v_mfma_f32_16x16x32_bf16 a[108:111], a[244:247], v[240:243], a[108:111]
    v_mfma_f32_16x16x32_bf16 a[112:115], a[244:247], v[244:247], a[112:115]
    s_add_u32 m0, s56, 126976
    s_add_u32 s42, s57, 32768
    buffer_load_dwordx4 v29, s[24:27], s42 offen offset:0 lds
    v_mfma_f32_16x16x32_bf16 a[116:119], a[244:247], v[248:251], a[116:119]
    v_mfma_f32_16x16x32_bf16 a[120:123], a[248:251], v[232:235], a[120:123]
    v_mfma_f32_16x16x32_bf16 a[124:127], a[248:251], v[236:239], a[124:127]
    s_add_u32 s42, s57, 39936
    buffer_load_dwordx4 v29, s[24:27], s42 offen offset:1024 lds
    v_mfma_f32_16x16x32_bf16 a[128:131], a[248:251], v[240:243], a[128:131]
    v_mfma_f32_16x16x32_bf16 a[132:135], a[248:251], v[244:247], a[132:135]
    v_mfma_f32_16x16x32_bf16 a[136:139], a[248:251], v[248:251], a[136:139]
    v_mfma_f32_16x16x32_bf16 a[140:143], a[252:255], v[232:235], a[140:143]
    s_add_u32 s42, s57, 47104
    buffer_load_dwordx4 v29, s[24:27], s42 offen offset:2048 lds
    v_mfma_f32_16x16x32_bf16 a[144:147], a[252:255], v[236:239], a[144:147]
    v_mfma_f32_16x16x32_bf16 a[148:151], a[252:255], v[240:243], a[148:151]
    v_mfma_f32_16x16x32_bf16 a[152:155], a[252:255], v[244:247], a[152:155]
    s_add_u32 s42, s57, 54272
    buffer_load_dwordx4 v29, s[24:27], s42 offen offset:3072 lds
    v_mfma_f32_16x16x32_bf16 a[156:159], a[252:255], v[248:251], a[156:159]
    s_waitcnt lgkmcnt(0)
    v_cmp_lt_u32 vcc, s61, v172
    s_nop 4
    s_cbranch_vccnz L_fallback
L_e1:
    s_mul_i32 s63, s32, 20480
    v_add_u32 v1, s63, v30
    v_rcp_f32 v52, v52
    v_rcp_f32 v56, v56
    v_rcp_f32 v60, v60
    v_rcp_f32 v64, v64
    ds_write_b128 v1, a[160:163] offset:0
    v_rcp_f32 v68, v68
    v_accvgpr_read_b32 v172, a0
    v_accvgpr_read_b32 v173, a1
    v_accvgpr_read_b32 v174, a2
    v_accvgpr_read_b32 v175, a3
    v_accvgpr_read_b32 v176, a20
    v_accvgpr_read_b32 v177, a21
    v_accvgpr_read_b32 v178, a22
    v_accvgpr_read_b32 v179, a23
    v_pk_mul_f32 v[172:173], v[172:173], v[52:53] op_sel_hi:[1,0]
    v_pk_mul_f32 v[174:175], v[174:175], v[52:53] op_sel_hi:[1,0]
    v_pk_mul_f32 v[176:177], v[176:177], v[52:53] op_sel_hi:[1,0]
    v_pk_mul_f32 v[178:179], v[178:179], v[52:53] op_sel_hi:[1,0]
    v_cvt_pk_bf16_f32 v92, v172, v173
    v_cvt_pk_bf16_f32 v93, v174, v175
    v_cvt_pk_bf16_f32 v94, v176, v177
    ds_write_b128 v1, a[164:167] offset:1024
    v_cvt_pk_bf16_f32 v95, v178, v179
    v_accvgpr_read_b32 v180, a4
    v_accvgpr_read_b32 v181, a5
    v_accvgpr_read_b32 v182, a6
    v_accvgpr_read_b32 v183, a7
    v_accvgpr_read_b32 v184, a24
    v_accvgpr_read_b32 v185, a25
    v_accvgpr_read_b32 v186, a26
    v_accvgpr_read_b32 v187, a27
    v_pk_mul_f32 v[180:181], v[180:181], v[56:57] op_sel_hi:[1,0]
    v_pk_mul_f32 v[182:183], v[182:183], v[56:57] op_sel_hi:[1,0]
    v_pk_mul_f32 v[184:185], v[184:185], v[56:57] op_sel_hi:[1,0]
    v_pk_mul_f32 v[186:187], v[186:187], v[56:57] op_sel_hi:[1,0]
    v_cvt_pk_bf16_f32 v96, v180, v181
    v_cvt_pk_bf16_f32 v97, v182, v183
    v_cvt_pk_bf16_f32 v98, v184, v185
    ds_write_b128 v1, a[168:171] offset:2048
    v_cvt_pk_bf16_f32 v99, v186, v187
    v_accvgpr_read_b32 v188, a8
    v_accvgpr_read_b32 v189, a9
    v_accvgpr_read_b32 v190, a10
    s_add_u32 m0, s56, 90112
    s_add_u32 s42, s58, 0
    buffer_load_dwordx4 v29, s[24:27], s42 offen offset:0 lds
    v_accvgpr_read_b32 v191, a11
    v_accvgpr_read_b32 v192, a28
    v_accvgpr_read_b32 v193, a29
    v_accvgpr_read_b32 v194, a30
    v_accvgpr_read_b32 v195, a31
    v_pk_mul_f32 v[188:189], v[188:189], v[60:61] op_sel_hi:[1,0]
    v_pk_mul_f32 v[190:191], v[190:191], v[60:61] op_sel_hi:[1,0]
    v_pk_mul_f32 v[192:193], v[192:193], v[60:61] op_sel_hi:[1,0]
    v_pk_mul_f32 v[194:195], v[194:195], v[60:61] op_sel_hi:[1,0]
    ds_write_b128 v1, a[172:175] offset:3072
    v_cvt_pk_bf16_f32 v100, v188, v189
    v_cvt_pk_bf16_f32 v101, v190, v191
    v_cvt_pk_bf16_f32 v102, v192, v193
    v_cvt_pk_bf16_f32 v103, v194, v195
    v_accvgpr_read_b32 v196, a12
    v_accvgpr_read_b32 v197, a13
    v_accvgpr_read_b32 v198, a14
    v_accvgpr_read_b32 v199, a15
    v_accvgpr_read_b32 v200, a32
    v_accvgpr_read_b32 v201, a33
    v_accvgpr_read_b32 v202, a34
    v_accvgpr_read_b32 v203, a35
    v_pk_mul_f32 v[196:197], v[196:197], v[64:65] op_sel_hi:[1,0]
    v_pk_mul_f32 v[198:199], v[198:199], v[64:65] op_sel_hi:[1,0]
    v_pk_mul_f32 v[200:201], v[200:201], v[64:65] op_sel_hi:[1,0]
    v_pk_mul_f32 v[202:203], v[202:203], v[64:65] op_sel_hi:[1,0]
    ds_write_b128 v1, a[176:179] offset:4096
    v_cvt_pk_bf16_f32 v104, v196, v197
    v_cvt_pk_bf16_f32 v105, v198, v199
    v_cvt_pk_bf16_f32 v106, v200, v201
    v_cvt_pk_bf16_f32 v107, v202, v203
    v_accvgpr_read_b32 v172, a16
    s_add_u32 s42, s58, 7168
    buffer_load_dwordx4 v29, s[24:27], s42 offen offset:1024 lds
    v_accvgpr_read_b32 v173, a17
    v_accvgpr_read_b32 v174, a18
    v_accvgpr_read_b32 v175, a19
    v_accvgpr_read_b32 v176, a36
    v_accvgpr_read_b32 v177, a37
    v_accvgpr_read_b32 v178, a38
    v_accvgpr_read_b32 v179, a39
    v_pk_mul_f32 v[172:173], v[172:173], v[68:69] op_sel_hi:[1,0]
    v_pk_mul_f32 v[174:175], v[174:175], v[68:69] op_sel_hi:[1,0]
    ds_write_b128 v1, a[180:183] offset:5120
    v_pk_mul_f32 v[176:177], v[176:177], v[68:69] op_sel_hi:[1,0]
    v_pk_mul_f32 v[178:179], v[178:179], v[68:69] op_sel_hi:[1,0]
    v_cvt_pk_bf16_f32 v108, v172, v173
    v_cvt_pk_bf16_f32 v109, v174, v175
    v_cvt_pk_bf16_f32 v110, v176, v177
    v_cvt_pk_bf16_f32 v111, v178, v179
    v_accvgpr_read_b32 v180, a40
    v_accvgpr_read_b32 v181, a41
    v_accvgpr_read_b32 v182, a42
    v_accvgpr_read_b32 v183, a43
    v_accvgpr_read_b32 v184, a60
    v_accvgpr_read_b32 v185, a61
    v_accvgpr_read_b32 v186, a62
    v_accvgpr_read_b32 v187, a63
    v_pk_mul_f32 v[180:181], v[180:181], v[52:53] op_sel_hi:[1,0]
    v_pk_mul_f32 v[182:183], v[182:183], v[52:53] op_sel_hi:[1,0]
    ds_write_b128 v1, a[184:187] offset:6144
    v_pk_mul_f32 v[184:185], v[184:185], v[52:53] op_sel_hi:[1,0]
    v_pk_mul_f32 v[186:187], v[186:187], v[52:53] op_sel_hi:[1,0]
    v_cvt_pk_bf16_f32 v112, v180, v181
    v_cvt_pk_bf16_f32 v113, v182, v183
    v_cvt_pk_bf16_f32 v114, v184, v185
    s_add_u32 s42, s58, 14336
    buffer_load_dwordx4 v29, s[24:27], s42 offen offset:2048 lds
    v_cvt_pk_bf16_f32 v115, v186, v187
    v_accvgpr_read_b32 v188, a44
    v_accvgpr_read_b32 v189, a45
    v_accvgpr_read_b32 v190, a46
    v_accvgpr_read_b32 v191, a47
    v_accvgpr_read_b32 v192, a64
    v_accvgpr_read_b32 v193, a65
    v_accvgpr_read_b32 v194, a66
    v_accvgpr_read_b32 v195, a67
    ds_write_b128 v1, a[188:191] offset:7168
    v_pk_mul_f32 v[188:189], v[188:189], v[56:57] op_sel_hi:[1,0]
    v_pk_mul_f32 v[190:191], v[190:191], v[56:57] op_sel_hi:[1,0]
    v_pk_mul_f32 v[192:193], v[192:193], v[56:57] op_sel_hi:[1,0]
    v_pk_mul_f32 v[194:195], v[194:195], v[56:57] op_sel_hi:[1,0]
    v_cvt_pk_bf16_f32 v116, v188, v189
    v_cvt_pk_bf16_f32 v117, v190, v191
    v_cvt_pk_bf16_f32 v118, v192, v193
    v_cvt_pk_bf16_f32 v119, v194, v195
    v_accvgpr_read_b32 v196, a48
    v_accvgpr_read_b32 v197, a49
    v_accvgpr_read_b32 v198, a50
    v_accvgpr_read_b32 v199, a51
    v_accvgpr_read_b32 v200, a68
    v_accvgpr_read_b32 v201, a69
    v_accvgpr_read_b32 v202, a70
    v_accvgpr_read_b32 v203, a71
    ds_write_b128 v1, a[192:195] offset:8192
    v_pk_mul_f32 v[196:197], v[196:197], v[60:61] op_sel_hi:[1,0]
    v_pk_mul_f32 v[198:199], v[198:199], v[60:61] op_sel_hi:[1,0]
    v_pk_mul_f32 v[200:201], v[200:201], v[60:61] op_sel_hi:[1,0]
    v_pk_mul_f32 v[202:203], v[202:203], v[60:61] op_sel_hi:[1,0]
    v_cvt_pk_bf16_f32 v120, v196, v197
    s_add_u32 s42, s58, 21504
    buffer_load_dwordx4 v29, s[24:27], s42 offen offset:3072 lds
    v_cvt_pk_bf16_f32 v121, v198, v199
    v_cvt_pk_bf16_f32 v122, v200, v201
    v_cvt_pk_bf16_f32 v123, v202, v203
    v_accvgpr_read_b32 v172, a52
    v_accvgpr_read_b32 v173, a53
    v_accvgpr_read_b32 v174, a54
    v_accvgpr_read_b32 v175, a55
    v_accvgpr_read_b32 v176, a72
    v_accvgpr_read_b32 v177, a73
    ds_write_b128 v1, a[196:199] offset:9216
    v_accvgpr_read_b32 v178, a74
    v_accvgpr_read_b32 v179, a75
    v_pk_mul_f32 v[172:173], v[172:173], v[64:65] op_sel_hi:[1,0]
    v_pk_mul_f32 v[174:175], v[174:175], v[64:65] op_sel_hi:[1,0]
    v_pk_mul_f32 v[176:177], v[176:177], v[64:65] op_sel_hi:[1,0]
    v_pk_mul_f32 v[178:179], v[178:179], v[64:65] op_sel_hi:[1,0]
    v_cvt_pk_bf16_f32 v124, v172, v173
    v_cvt_pk_bf16_f32 v125, v174, v175
    v_cvt_pk_bf16_f32 v126, v176, v177
    v_cvt_pk_bf16_f32 v127, v178, v179
    v_accvgpr_read_b32 v180, a56
    v_accvgpr_read_b32 v181, a57
    v_accvgpr_read_b32 v182, a58
    v_accvgpr_read_b32 v183, a59
    v_accvgpr_read_b32 v184, a76
    v_accvgpr_read_b32 v185, a77
    s_waitcnt lgkmcnt(8)
    ds_write_b128 v1, a[200:203] offset:10240
    v_accvgpr_read_b32 v186, a78
    v_accvgpr_read_b32 v187, a79
    v_pk_mul_f32 v[180:181], v[180:181], v[68:69] op_sel_hi:[1,0]
    v_pk_mul_f32 v[182:183], v[182:183], v[68:69] op_sel_hi:[1,0]
    v_pk_mul_f32 v[184:185], v[184:185], v[68:69] op_sel_hi:[1,0]
    s_add_u32 m0, s56, 94208
    s_add_u32 s42, s58, 32768
    buffer_load_dwordx4 v29, s[24:27], s42 offen offset:0 lds
    v_pk_mul_f32 v[186:187], v[186:187], v[68:69] op_sel_hi:[1,0]
    v_cvt_pk_bf16_f32 v128, v180, v181
    v_cvt_pk_bf16_f32 v129, v182, v183
    v_cvt_pk_bf16_f32 v130, v184, v185
    v_cvt_pk_bf16_f32 v131, v186, v187
    v_accvgpr_read_b32 v188, a80
    v_accvgpr_read_b32 v189, a81
    v_accvgpr_read_b32 v190, a82
    ds_write_b128 v1, a[204:207] offset:11264
    v_accvgpr_read_b32 v191, a83
    v_accvgpr_read_b32 v192, a100
    v_accvgpr_read_b32 v193, a101
    v_accvgpr_read_b32 v194, a102
    v_accvgpr_read_b32 v195, a103
    v_pk_mul_f32 v[188:189], v[188:189], v[52:53] op_sel_hi:[1,0]
    v_pk_mul_f32 v[190:191], v[190:191], v[52:53] op_sel_hi:[1,0]
    v_pk_mul_f32 v[192:193], v[192:193], v[52:53] op_sel_hi:[1,0]
    v_pk_mul_f32 v[194:195], v[194:195], v[52:53] op_sel_hi:[1,0]
    v_cvt_pk_bf16_f32 v132, v188, v189
    v_cvt_pk_bf16_f32 v133, v190, v191
    v_cvt_pk_bf16_f32 v134, v192, v193
    v_cvt_pk_bf16_f32 v135, v194, v195
    v_accvgpr_read_b32 v196, a84
    v_accvgpr_read_b32 v197, a85
    v_accvgpr_read_b32 v198, a86
    ds_write_b128 v1, a[208:211] offset:12288
    v_accvgpr_read_b32 v199, a87
    v_accvgpr_read_b32 v200, a104
    v_accvgpr_read_b32 v201, a105
    v_accvgpr_read_b32 v202, a106
    v_accvgpr_read_b32 v203, a107
    v_pk_mul_f32 v[196:197], v[196:197], v[56:57] op_sel_hi:[1,0]
    s_add_u32 s42, s58, 39936
    buffer_load_dwordx4 v29, s[24:27], s42 offen offset:1024 lds
    v_pk_mul_f32 v[198:199], v[198:199], v[56:57] op_sel_hi:[1,0]
    v_pk_mul_f32 v[200:201], v[200:201], v[56:57] op_sel_hi:[1,0]
    v_pk_mul_f32 v[202:203], v[202:203], v[56:57] op_sel_hi:[1,0]
    v_cvt_pk_bf16_f32 v136, v196, v197
    v_cvt_pk_bf16_f32 v137, v198, v199
    v_cvt_pk_bf16_f32 v138, v200, v201
    v_cvt_pk_bf16_f32 v139, v202, v203
    v_accvgpr_read_b32 v172, a88
    ds_write_b128 v1, a[212:215] offset:13312
    v_accvgpr_read_b32 v173, a89
    v_accvgpr_read_b32 v174, a90
    v_accvgpr_read_b32 v175, a91
    v_accvgpr_read_b32 v176, a108
    v_accvgpr_read_b32 v177, a109
    v_accvgpr_read_b32 v178, a110
    v_accvgpr_read_b32 v179, a111
    v_pk_mul_f32 v[172:173], v[172:173], v[60:61] op_sel_hi:[1,0]
    v_pk_mul_f32 v[174:175], v[174:175], v[60:61] op_sel_hi:[1,0]
    v_pk_mul_f32 v[176:177], v[176:177], v[60:61] op_sel_hi:[1,0]
    v_pk_mul_f32 v[178:179], v[178:179], v[60:61] op_sel_hi:[1,0]
    v_cvt_pk_bf16_f32 v140, v172, v173
    v_cvt_pk_bf16_f32 v141, v174, v175
    v_cvt_pk_bf16_f32 v142, v176, v177
    v_cvt_pk_bf16_f32 v143, v178, v179
    v_accvgpr_read_b32 v180, a92
    ds_write_b128 v1, a[216:219] offset:14336
    v_accvgpr_read_b32 v181, a93
    v_accvgpr_read_b32 v182, a94
    v_accvgpr_read_b32 v183, a95
    v_accvgpr_read_b32 v184, a112
    v_accvgpr_read_b32 v185, a113
    v_accvgpr_read_b32 v186, a114
    s_add_u32 s42, s58, 47104
    buffer_load_dwordx4 v29, s[24:27], s42 offen offset:2048 lds
    v_accvgpr_read_b32 v187, a115
    v_pk_mul_f32 v[180:181], v[180:181], v[64:65] op_sel_hi:[1,0]
    v_pk_mul_f32 v[182:183], v[182:183], v[64:65] op_sel_hi:[1,0]
    v_pk_mul_f32 v[184:185], v[184:185], v[64:65] op_sel_hi:[1,0]
    v_pk_mul_f32 v[186:187], v[186:187], v[64:65] op_sel_hi:[1,0]
    v_cvt_pk_bf16_f32 v144, v180, v181
    v_cvt_pk_bf16_f32 v145, v182, v183
    v_cvt_pk_bf16_f32 v146, v184, v185
    s_waitcnt lgkmcnt(8)
    ds_write_b128 v1, a[220:223] offset:15360
    v_cvt_pk_bf16_f32 v147, v186, v187
    v_accvgpr_read_b32 v188, a96
    v_accvgpr_read_b32 v189, a97
    v_accvgpr_read_b32 v190, a98
    v_accvgpr_read_b32 v191, a99
    v_accvgpr_read_b32 v192, a116
    v_accvgpr_read_b32 v193, a117
    v_accvgpr_read_b32 v194, a118
    v_accvgpr_read_b32 v195, a119
    v_pk_mul_f32 v[188:189], v[188:189], v[68:69] op_sel_hi:[1,0]
    v_pk_mul_f32 v[190:191], v[190:191], v[68:69] op_sel_hi:[1,0]
    v_pk_mul_f32 v[192:193], v[192:193], v[68:69] op_sel_hi:[1,0]
    v_pk_mul_f32 v[194:195], v[194:195], v[68:69] op_sel_hi:[1,0]
    v_cvt_pk_bf16_f32 v148, v188, v189
    v_cvt_pk_bf16_f32 v149, v190, v191
    v_cvt_pk_bf16_f32 v150, v192, v193
    ds_write_b128 v1, a[224:227] offset:16384
    v_cvt_pk_bf16_f32 v151, v194, v195
    v_accvgpr_read_b32 v196, a120
    v_accvgpr_read_b32 v197, a121
    v_accvgpr_read_b32 v198, a122
    v_accvgpr_read_b32 v199, a123
    v_accvgpr_read_b32 v200, a140
    s_add_u32 s42, s58, 54272
    buffer_load_dwordx4 v29, s[24:27], s42 offen offset:3072 lds
    s_add_u32 s59, s59, 128
    s_and_b32 s59, s59, 1023
    s_add_u32 s57, s66, s59
    s_add_u32 s58, s67, s59
    v_accvgpr_read_b32 v201, a141
    v_accvgpr_read_b32 v202, a142
    v_accvgpr_read_b32 v203, a143
    v_pk_mul_f32 v[196:197], v[196:197], v[52:53] op_sel_hi:[1,0]
    ds_write_b128 v1, a[228:231] offset:17408
    v_pk_mul_f32 v[198:199], v[198:199], v[52:53] op_sel_hi:[1,0]
    v_pk_mul_f32 v[200:201], v[200:201], v[52:53] op_sel_hi:[1,0]
    v_pk_mul_f32 v[202:203], v[202:203], v[52:53] op_sel_hi:[1,0]
    v_cvt_pk_bf16_f32 v152, v196, v197
    v_cvt_pk_bf16_f32 v153, v198, v199
    v_cvt_pk_bf16_f32 v154, v200, v201
    v_cvt_pk_bf16_f32 v155, v202, v203
    v_accvgpr_read_b32 v172, a124
    v_accvgpr_read_b32 v173, a125
    v_accvgpr_read_b32 v174, a126
    v_accvgpr_read_b32 v175, a127
    v_accvgpr_read_b32 v176, a144
    v_accvgpr_read_b32 v177, a145
    v_accvgpr_read_b32 v178, a146
    v_accvgpr_read_b32 v179, a147
    v_pk_mul_f32 v[172:173], v[172:173], v[56:57] op_sel_hi:[1,0]
    ds_write_b128 v1, a[232:235] offset:18432
    v_pk_mul_f32 v[174:175], v[174:175], v[56:57] op_sel_hi:[1,0]
    v_pk_mul_f32 v[176:177], v[176:177], v[56:57] op_sel_hi:[1,0]
    v_pk_mul_f32 v[178:179], v[178:179], v[56:57] op_sel_hi:[1,0]
    v_cvt_pk_bf16_f32 v156, v172, v173
    v_cvt_pk_bf16_f32 v157, v174, v175
    v_cvt_pk_bf16_f32 v158, v176, v177
    v_cvt_pk_bf16_f32 v159, v178, v179
    v_accvgpr_read_b32 v180, a128
    v_accvgpr_read_b32 v181, a129
    v_accvgpr_read_b32 v182, a130
    v_accvgpr_read_b32 v183, a131
    v_accvgpr_read_b32 v184, a148
    v_accvgpr_read_b32 v185, a149
    v_accvgpr_read_b32 v186, a150
    v_accvgpr_read_b32 v187, a151
    v_pk_mul_f32 v[180:181], v[180:181], v[60:61] op_sel_hi:[1,0]
    ds_write_b128 v1, a[236:239] offset:19456
    v_pk_mul_f32 v[182:183], v[182:183], v[60:61] op_sel_hi:[1,0]
    v_pk_mul_f32 v[184:185], v[184:185], v[60:61] op_sel_hi:[1,0]
    v_pk_mul_f32 v[186:187], v[186:187], v[60:61] op_sel_hi:[1,0]
    v_cvt_pk_bf16_f32 v160, v180, v181
    v_cvt_pk_bf16_f32 v161, v182, v183
    v_cvt_pk_bf16_f32 v162, v184, v185
    v_cvt_pk_bf16_f32 v163, v186, v187
    v_accvgpr_read_b32 v188, a132
    v_accvgpr_read_b32 v189, a133
    v_accvgpr_read_b32 v190, a134
    v_accvgpr_read_b32 v191, a135
    v_accvgpr_read_b32 v192, a152
    v_accvgpr_read_b32 v193, a153
    v_accvgpr_read_b32 v194, a154
    v_accvgpr_read_b32 v195, a155
    v_pk_mul_f32 v[188:189], v[188:189], v[64:65] op_sel_hi:[1,0]
    v_pk_mul_f32 v[190:191], v[190:191], v[64:65] op_sel_hi:[1,0]
    v_pk_mul_f32 v[192:193], v[192:193], v[64:65] op_sel_hi:[1,0]
    v_pk_mul_f32 v[194:195], v[194:195], v[64:65] op_sel_hi:[1,0]
    v_cvt_pk_bf16_f32 v164, v188, v189
    v_cvt_pk_bf16_f32 v165, v190, v191
    v_cvt_pk_bf16_f32 v166, v192, v193
    v_cvt_pk_bf16_f32 v167, v194, v195
    v_accvgpr_read_b32 v196, a136
    v_accvgpr_read_b32 v197, a137
    v_accvgpr_read_b32 v198, a138
    v_accvgpr_read_b32 v199, a139
    v_accvgpr_read_b32 v200, a156
    v_accvgpr_read_b32 v201, a157
    v_accvgpr_read_b32 v202, a158
    v_accvgpr_read_b32 v203, a159
    v_pk_mul_f32 v[196:197], v[196:197], v[68:69] op_sel_hi:[1,0]
    v_pk_mul_f32 v[198:199], v[198:199], v[68:69] op_sel_hi:[1,0]
    v_pk_mul_f32 v[200:201], v[200:201], v[68:69] op_sel_hi:[1,0]
    v_pk_mul_f32 v[202:203], v[202:203], v[68:69] op_sel_hi:[1,0]
    v_cvt_pk_bf16_f32 v168, v196, v197
    v_cvt_pk_bf16_f32 v169, v198, v199
    v_cvt_pk_bf16_f32 v170, v200, v201
    v_cvt_pk_bf16_f32 v171, v202, v203
    s_xor_b32 s63, s32, 2
    s_mul_i32 s63, s63, 20480
    v_add_u32 v2, s63, v30
    s_load_dwordx4 s[8:11], s[0:1], 80
    s_waitcnt vmcnt(8) lgkmcnt(0)
    s_barrier
    ds_read_b128 a[0:3], v2 offset:0
    s_mov_b64 s[12:13], s[8:9]
    s_and_b32 s13, s13, 0xffff
    s_mov_b32 s14, 5242880
    ds_read_b128 a[4:7], v2 offset:1024
    s_mov_b32 s15, 0x20000
    s_mov_b64 s[8:9], s[10:11]
    s_and_b32 s9, s9, 0xffff
    ds_read_b128 a[8:11], v2 offset:2048
    s_mov_b32 s10, 256
    s_mov_b32 s11, 0x20000
    s_add_u32 s16, s88, 50331648
    ds_read_b128 a[12:15], v2 offset:3072
    s_addc_u32 s17, s89, 0
    s_and_b32 s17, s17, 0xffff
    s_mov_b32 s18, 32768
    ds_read_b128 a[16:19], v2 offset:4096
    s_mov_b32 s19, 0x20000
    s_mul_i32 s63, s96, 1310720
    s_add_u32 s20, s88, s63
    ds_read_b128 a[20:23], v2 offset:5120
    s_addc_u32 s21, s89, 0
    s_and_b32 s21, s21, 0xffff
    s_mov_b32 s22, 0
    ds_read_b128 a[24:27], v2 offset:6144
    s_mov_b32 s23, 0x20000
    s_mov_b64 s[28:29], s[20:21]
    s_mov_b32 s30, 1310720
    ds_read_b128 a[28:31], v2 offset:7168
    s_mov_b32 s31, 0x20000
    s_mul_i32 s51, s97, 20480
    s_mul_i32 s52, s32, 5120
    ds_read_b128 a[32:35], v2 offset:8192
    s_lshl_b32 s54, s96, 10
    s_lshl_b32 s41, s97, 7
    s_add_u32 s41, s41, s54
    ds_read_b128 a[36:39], v2 offset:9216
    s_mov_b32 s38, 0x7ff00000
    s_mov_b32 s64, s97
    s_add_u32 s64, s64, 1
    ds_read_b128 a[40:43], v2 offset:10240
    s_and_b32 s64, s64, 7
    s_mul_i32 s60, s64, 163840
    s_add_u32 s60, s60, s51
    ds_read_b128 a[44:47], v2 offset:11264
    s_add_u32 s60, s60, s52
    s_add_u32 s37, s60, 4096
    s_mul_i32 s53, s97, 163840
    ds_read_b128 a[48:51], v2 offset:12288
    s_add_u32 s53, s53, s52
    s_add_u32 s65, s97, 1
    s_mov_b32 s50, 0
    ds_read_b128 a[52:55], v2 offset:13312
    s_mov_b32 s39, 0
    s_mov_b32 s40, 0
    s_mov_b32 s55, s26
    s_waitcnt lgkmcnt(8)
    ds_read_b128 a[56:59], v2 offset:14336
    s_mov_b32 s36, 0
    v_mov_b32 v8, v29
    v_mov_b32 v9, v30
    ds_read_b128 a[60:63], v2 offset:15360
    v_add_u32 v4, 90112, v252
    v_xor_b32 v6, 0x4000, v252
    v_add_u32 v6, 90112, v6
    ds_read_b128 a[64:67], v2 offset:16384
    v_add_u32 v5, 90112, v253
    v_xor_b32 v7, 0x4000, v253
    v_add_u32 v7, 90112, v7
    ds_read_b128 a[68:71], v2 offset:17408
    v_and_b32 v20, 15, v0
    v_bfe_u32 v21, v0, 4, 2
    v_cmp_eq_u32 vcc, 0, v0
    ds_read_b128 a[72:75], v2 offset:18432
    v_mov_b32 v23, 0x7ff00000
    s_lshl_b32 s62, 1, s97
    v_cndmask_b32 v10, v23, 0, vcc
    ds_read_b128 a[76:79], v2 offset:19456
    v_mov_b32 v11, s62
    v_lshrrev_b32 v22, 2, v20
    v_sub_u32 v22, v22, v21
    v_and_b32 v20, 3, v20
    v_lshl_add_u32 v22, v22, 3, v20
    v_mov_b32 v23, 0x3f80
    v_mov_b32 v21, 0x3f800000
    v_cmp_eq_u32 vcc, 0, v22
    v_mov_b32 v14, 0
    v_mov_b32 v16, 0
    v_cndmask_b32 v12, 0, v23, vcc
    v_cmp_eq_u32 vcc, 1, v22
    s_nop 1
    v_cndmask_b32 v12, v12, v21, vcc
    v_mov_b32 v18, v12
    v_cmp_eq_u32 vcc, 2, v22
    v_mov_b32 v15, 0
    v_mov_b32 v17, 0
    v_cndmask_b32 v13, 0, v23, vcc
    v_cmp_eq_u32 vcc, 3, v22
    s_nop 1
    v_cndmask_b32 v13, v13, v21, vcc
    v_mov_b32 v19, v13
    s_lshl_b32 s3, s96, 3
    s_cmp_eq_u32 s32, 0
    s_cselect_b32 s3, s3, 0x7ff00000
    v_mov_b32 v34, s3
    s_cselect_b32 s63, 0, 0xff
    buffer_load_dword v35, v34, s[8:11], 0 offen sc1
    s_waitcnt lgkmcnt(8)
    ds_read_b64_tr_b16 a[240:241], v4 offset:32768
    ds_read_b64_tr_b16 a[242:243], v4 offset:34816
    ds_read_b64_tr_b16 a[244:245], v5 offset:32768
    ds_read_b64_tr_b16 a[246:247], v5 offset:34816
    ds_read_b64_tr_b16 a[248:249], v4 offset:36864
    ds_read_b64_tr_b16 a[250:251], v4 offset:38912
    s_waitcnt lgkmcnt(0)
    s_barrier
    v_mfma_f32_16x16x32_bf16 v[172:175], a[240:243], a[160:163], 0
    ds_read_b64_tr_b16 a[252:253], v5 offset:36864
    ds_read_b64_tr_b16 a[254:255], v5 offset:38912
    v_mfma_f32_16x16x32_bf16 v[176:179], a[240:243], a[164:167], 0
    ds_write_b128 v1, v[92:95] offset:0
    v_mfma_f32_16x16x32_bf16 v[180:183], a[240:243], a[168:171], 0
    v_mov_b32 v52, 0
    v_mov_b32 v53, 0
    v_mfma_f32_16x16x32_bf16 v[184:187], a[240:243], a[172:175], 0
    ds_write_b128 v1, v[96:99] offset:1024
    v_mfma_f32_16x16x32_bf16 v[188:191], a[240:243], a[176:179], 0
    v_mov_b32 v54, 0
    v_mov_b32 v55, 0
    v_mfma_f32_16x16x32_bf16 v[192:195], a[244:247], a[160:163], 0
    ds_read_b64_tr_b16 a[240:241], v4 offset:40960
    ds_read_b64_tr_b16 a[242:243], v4 offset:43008
    v_mfma_f32_16x16x32_bf16 v[196:199], a[244:247], a[164:167], 0
    ds_write_b128 v1, v[100:103] offset:2048
    v_mfma_f32_16x16x32_bf16 v[200:203], a[244:247], a[168:171], 0
    v_mov_b32 v56, 0
    v_mov_b32 v57, 0
    v_mfma_f32_16x16x32_bf16 v[204:207], a[244:247], a[172:175], 0
    ds_write_b128 v1, v[104:107] offset:3072
    v_mfma_f32_16x16x32_bf16 v[208:211], a[244:247], a[176:179], 0
    v_mov_b32 v58, 0
    v_mov_b32 v59, 0
    v_mfma_f32_16x16x32_bf16 v[172:175], a[248:251], a[180:183], v[172:175]
    ds_read_b64_tr_b16 a[244:245], v5 offset:40960
    ds_read_b64_tr_b16 a[246:247], v5 offset:43008
    v_mfma_f32_16x16x32_bf16 v[176:179], a[248:251], a[184:187], v[176:179]
    ds_write_b128 v1, v[108:111] offset:4096
    v_mfma_f32_16x16x32_bf16 v[180:183], a[248:251], a[188:191], v[180:183]
    v_mov_b32 v60, 0
    v_mov_b32 v61, 0
    v_mfma_f32_16x16x32_bf16 v[184:187], a[248:251], a[192:195], v[184:187]
    ds_write_b128 v1, v[112:115] offset:5120
    v_mfma_f32_16x16x32_bf16 v[188:191], a[248:251], a[196:199], v[188:191]
    s_waitcnt lgkmcnt(10)
    v_mov_b32 v62, 0
    v_mov_b32 v63, 0
    v_mfma_f32_16x16x32_bf16 v[192:195], a[252:255], a[180:183], v[192:195]
    ds_read_b64_tr_b16 a[248:249], v4 offset:45056
    ds_read_b64_tr_b16 a[250:251], v4 offset:47104
    v_mfma_f32_16x16x32_bf16 v[196:199], a[252:255], a[184:187], v[196:199]
    ds_write_b128 v1, v[116:119] offset:6144
    v_mfma_f32_16x16x32_bf16 v[200:203], a[252:255], a[188:191], v[200:203]
    v_mov_b32 v64, 0
    v_mov_b32 v65, 0
    v_mfma_f32_16x16x32_bf16 v[204:207], a[252:255], a[192:195], v[204:207]
    ds_write_b128 v1, v[120:123] offset:7168
    v_mfma_f32_16x16x32_bf16 v[208:211], a[252:255], a[196:199], v[208:211]
    s_waitcnt lgkmcnt(10)
    v_mov_b32 v66, 0
    v_mov_b32 v67, 0
    v_mfma_f32_16x16x32_bf16 v[172:175], a[240:243], a[200:203], v[172:175]
    ds_read_b64_tr_b16 a[252:253], v5 offset:45056
    ds_read_b64_tr_b16 a[254:255], v5 offset:47104
    v_mfma_f32_16x16x32_bf16 v[176:179], a[240:243], a[204:207], v[176:179]
    ds_write_b128 v1, v[124:127] offset:8192
    v_mfma_f32_16x16x32_bf16 v[180:183], a[240:243], a[208:211], v[180:183]
    v_mov_b32 v68, 0
    v_mov_b32 v69, 0
    v_mfma_f32_16x16x32_bf16 v[184:187], a[240:243], a[212:215], v[184:187]
    ds_write_b128 v1, v[128:131] offset:9216
    v_mfma_f32_16x16x32_bf16 v[188:191], a[240:243], a[216:219], v[188:191]
    s_waitcnt lgkmcnt(10)
    v_mov_b32 v70, 0
    v_mov_b32 v71, 0
    v_mfma_f32_16x16x32_bf16 v[192:195], a[244:247], a[200:203], v[192:195]
    ds_read_b64_tr_b16 a[240:241], v6 offset:32768
    ds_read_b64_tr_b16 a[242:243], v6 offset:34816
    v_mfma_f32_16x16x32_bf16 v[196:199], a[244:247], a[204:207], v[196:199]
    ds_write_b128 v1, v[132:135] offset:10240
    v_mfma_f32_16x16x32_bf16 v[200:203], a[244:247], a[208:211], v[200:203]
    v_mov_b32 v72, 0
    v_mov_b32 v73, 0
    v_mfma_f32_16x16x32_bf16 v[204:207], a[244:247], a[212:215], v[204:207]
    ds_write_b128 v1, v[136:139] offset:11264
    v_mfma_f32_16x16x32_bf16 v[208:211], a[244:247], a[216:219], v[208:211]
    s_waitcnt lgkmcnt(10)
    v_mov_b32 v74, 0
    v_mov_b32 v75, 0
    v_mfma_f32_16x16x32_bf16 v[172:175], a[248:251], a[220:223], v[172:175]
    ds_read_b64_tr_b16 a[244:245], v7 offset:32768
    ds_read_b64_tr_b16 a[246:247], v7 offset:34816
    v_mfma_f32_16x16x32_bf16 v[176:179], a[248:251], a[224:227], v[176:179]
    ds_write_b128 v1, v[140:143] offset:12288
    v_mfma_f32_16x16x32_bf16 v[180:183], a[248:251], a[228:231], v[180:183]
    v_mov_b32 v76, 0
    v_mov_b32 v77, 0
    v_mfma_f32_16x16x32_bf16 v[184:187], a[248:251], a[232:235], v[184:187]
    ds_write_b128 v1, v[144:147] offset:13312
    v_mfma_f32_16x16x32_bf16 v[188:191], a[248:251], a[236:239], v[188:191]
    s_waitcnt lgkmcnt(10)
    v_mov_b32 v78, 0
    v_mov_b32 v79, 0
    v_mfma_f32_16x16x32_bf16 v[192:195], a[252:255], a[220:223], v[192:195]
    ds_read_b64_tr_b16 a[248:249], v6 offset:36864
    ds_read_b64_tr_b16 a[250:251], v6 offset:38912
    v_mfma_f32_16x16x32_bf16 v[196:199], a[252:255], a[224:227], v[196:199]
    ds_write_b128 v1, v[148:151] offset:14336
    v_mfma_f32_16x16x32_bf16 v[200:203], a[252:255], a[228:231], v[200:203]
    v_mov_b32 v80, 0
    v_mov_b32 v81, 0
    v_mfma_f32_16x16x32_bf16 v[204:207], a[252:255], a[232:235], v[204:207]
    ds_write_b128 v1, v[152:155] offset:15360
    v_mfma_f32_16x16x32_bf16 v[208:211], a[252:255], a[236:239], v[208:211]
    s_waitcnt lgkmcnt(10)
    v_mov_b32 v82, 0
    v_mov_b32 v83, 0
    v_mfma_f32_16x16x32_bf16 v[172:175], a[240:243], a[0:3], v[172:175]
    ds_read_b64_tr_b16 a[252:253], v7 offset:36864
    ds_read_b64_tr_b16 a[254:255], v7 offset:38912
    v_mfma_f32_16x16x32_bf16 v[176:179], a[240:243], a[4:7], v[176:179]
    ds_write_b128 v1, v[156:159] offset:16384
    v_mfma_f32_16x16x32_bf16 v[180:183], a[240:243], a[8:11], v[180:183]
    v_mov_b32 v84, 0
    v_mov_b32 v85, 0
    v_mfma_f32_16x16x32_bf16 v[184:187], a[240:243], a[12:15], v[184:187]
    ds_write_b128 v1, v[160:163] offset:17408
    v_mfma_f32_16x16x32_bf16 v[188:191], a[240:243], a[16:19], v[188:191]
    s_waitcnt lgkmcnt(10)
    v_mov_b32 v86, 0
    v_mov_b32 v87, 0
    v_mfma_f32_16x16x32_bf16 v[192:195], a[244:247], a[0:3], v[192:195]
    ds_read_b64_tr_b16 a[240:241], v6 offset:40960
    ds_read_b64_tr_b16 a[242:243], v6 offset:43008
    v_mfma_f32_16x16x32_bf16 v[196:199], a[244:247], a[4:7], v[196:199]
    ds_write_b128 v1, v[164:167] offset:18432
    v_mfma_f32_16x16x32_bf16 v[200:203], a[244:247], a[8:11], v[200:203]
    v_mov_b32 v88, 0
    v_mov_b32 v89, 0
    v_mfma_f32_16x16x32_bf16 v[204:207], a[244:247], a[12:15], v[204:207]
    ds_write_b128 v1, v[168:171] offset:19456
    v_mfma_f32_16x16x32_bf16 v[208:211], a[244:247], a[16:19], v[208:211]
    s_waitcnt lgkmcnt(10)
    v_mov_b32 v90, 0
    v_mov_b32 v91, 0
    v_mfma_f32_16x16x32_bf16 v[172:175], a[248:251], a[20:23], v[172:175]
    ds_read_b64_tr_b16 a[244:245], v7 offset:40960
    ds_read_b64_tr_b16 a[246:247], v7 offset:43008
    v_mfma_f32_16x16x32_bf16 v[176:179], a[248:251], a[24:27], v[176:179]
    v_mov_b32 v20, 0
    v_mov_b32 v21, 0
    v_mfma_f32_16x16x32_bf16 v[180:183], a[248:251], a[28:31], v[180:183]
    s_waitcnt vmcnt(0)
    v_readfirstlane_b32 s3, v35
    s_nop 1
    s_or_b32 s3, s3, s63
    s_and_b32 s3, s3, 0xff
    s_cmp_eq_u32 s3, 0xff
    s_cbranch_scc0 L_spinR
L_goR:
    v_mfma_f32_16x16x32_bf16 v[184:187], a[248:251], a[32:35], v[184:187]
    s_waitcnt lgkmcnt(0)
    s_barrier
    v_mfma_f32_16x16x32_bf16 v[188:191], a[248:251], a[36:39], v[188:191]
    ds_read_b128 a[80:83], v2 offset:0
    ds_read_b128 a[84:87], v2 offset:1024
    v_mfma_f32_16x16x32_bf16 v[192:195], a[252:255], a[20:23], v[192:195]
    ds_read_b64_tr_b16 a[248:249], v6 offset:45056
    ds_read_b64_tr_b16 a[250:251], v6 offset:47104
    v_mfma_f32_16x16x32_bf16 v[196:199], a[252:255], a[24:27], v[196:199]
    ds_read_b128 a[88:91], v2 offset:2048
    ds_read_b128 a[92:95], v2 offset:3072
    v_mfma_f32_16x16x32_bf16 v[200:203], a[252:255], a[28:31], v[200:203]
    ds_read_b128 a[96:99], v2 offset:4096
    ds_read_b128 a[100:103], v2 offset:5120
    v_mfma_f32_16x16x32_bf16 v[204:207], a[252:255], a[32:35], v[204:207]
    ds_read_b128 a[104:107], v2 offset:6144
    ds_read_b128 a[108:111], v2 offset:7168
    v_mfma_f32_16x16x32_bf16 v[208:211], a[252:255], a[36:39], v[208:211]
    ds_read_b128 a[112:115], v2 offset:8192
    ds_read_b128 a[116:119], v2 offset:9216
    v_mfma_f32_16x16x32_bf16 v[172:175], a[240:243], a[40:43], v[172:175]
    ds_read_b64_tr_b16 a[252:253], v7 offset:45056
    ds_read_b64_tr_b16 a[254:255], v7 offset:47104
    v_mfma_f32_16x16x32_bf16 v[176:179], a[240:243], a[44:47], v[176:179]
    s_waitcnt lgkmcnt(6)
    ds_read_b128 a[120:123], v2 offset:10240
    ds_read_b128 a[124:127], v2 offset:11264
    v_mfma_f32_16x16x32_bf16 v[180:183], a[240:243], a[48:51], v[180:183]
    ds_read_b128 a[128:131], v2 offset:12288
    ds_read_b128 a[132:135], v2 offset:13312
    v_mfma_f32_16x16x32_bf16 v[184:187], a[240:243], a[52:55], v[184:187]
    ds_read_b128 a[136:139], v2 offset:14336
    ds_read_b128 a[140:143], v2 offset:15360
    v_mfma_f32_16x16x32_bf16 v[188:191], a[240:243], a[56:59], v[188:191]
    s_waitcnt lgkmcnt(6)
    ds_read_b128 a[144:147], v2 offset:16384
    ds_read_b128 a[148:151], v2 offset:17408
    v_mfma_f32_16x16x32_bf16 v[192:195], a[244:247], a[40:43], v[192:195]
    ds_read_b128 a[152:155], v2 offset:18432
    ds_read_b128 a[156:159], v2 offset:19456
    v_mfma_f32_16x16x32_bf16 v[196:199], a[244:247], a[44:47], v[196:199]
    v_mov_b32 v22, 0
    v_mov_b32 v23, 0
    v_mov_b32 v24, 0
    v_mov_b32 v25, 0
    v_mfma_f32_16x16x32_bf16 v[200:203], a[244:247], a[48:51], v[200:203]
    v_mov_b32 v26, 0
    v_mov_b32 v27, 0
    v_mov_b32 v28, 0
    v_mov_b32 v29, 0
    v_mfma_f32_16x16x32_bf16 v[204:207], a[244:247], a[52:55], v[204:207]
    v_mov_b32 v30, 0
    v_mov_b32 v31, 0
    v_mov_b32 v252, 0
    v_mov_b32 v253, 0
    v_mfma_f32_16x16x32_bf16 v[208:211], a[244:247], a[56:59], v[208:211]
    v_mov_b32 v254, 0
    v_mov_b32 v255, 0
    v_mov_b32 v0, 0
    v_mov_b32 v1, 0
    v_mfma_f32_16x16x32_bf16 v[172:175], a[248:251], a[60:63], v[172:175]
    s_waitcnt lgkmcnt(0)
    s_barrier
    v_mfma_f32_16x16x32_bf16 v[176:179], a[248:251], a[64:67], v[176:179]
    s_add_u32 m0, s56, 0
    s_add_u32 s42, s57, 0
    ds_read_b64_tr_b16 a[240:241], v4 offset:0
    ds_read_b64_tr_b16 a[242:243], v4 offset:2048
    buffer_load_dwordx4 v8, s[24:27], s42 offen offset:0 lds
    v_mfma_f32_16x16x32_bf16 v[180:183], a[248:251], a[68:71], v[180:183]
    s_add_u32 s42, s57, 7168
    ds_read_b64_tr_b16 a[244:245], v5 offset:0
    ds_read_b64_tr_b16 a[246:247], v5 offset:2048
    buffer_load_dwordx4 v8, s[24:27], s42 offen offset:1024 lds
    v_mfma_f32_16x16x32_bf16 v[184:187], a[248:251], a[72:75], v[184:187]
    s_add_u32 s42, s57, 14336
    buffer_load_dwordx4 v8, s[24:27], s42 offen offset:2048 lds
    v_mfma_f32_16x16x32_bf16 v[188:191], a[248:251], a[76:79], v[188:191]
    s_add_u32 s42, s57, 21504
    buffer_load_dwordx4 v8, s[24:27], s42 offen offset:3072 lds
    v_mfma_f32_16x16x32_bf16 v[192:195], a[252:255], a[60:63], v[192:195]
    s_add_u32 m0, s56, 4096
    s_add_u32 s42, s57, 32768
    ds_read_b64_tr_b16 a[248:249], v4 offset:4096
    ds_read_b64_tr_b16 a[250:251], v4 offset:6144
    buffer_load_dwordx4 v8, s[24:27], s42 offen offset:0 lds
    v_mfma_f32_16x16x32_bf16 v[196:199], a[252:255], a[64:67], v[196:199]
    s_add_u32 s42, s57, 39936
    buffer_load_dwordx4 v8, s[24:27], s42 offen offset:1024 lds
    v_mfma_f32_16x16x32_bf16 v[200:203], a[252:255], a[68:71], v[200:203]
    s_add_u32 s42, s57, 47104
    buffer_load_dwordx4 v8, s[24:27], s42 offen offset:2048 lds
    v_mfma_f32_16x16x32_bf16 v[204:207], a[252:255], a[72:75], v[204:207]
    s_add_u32 s42, s57, 54272
    buffer_load_dwordx4 v8, s[24:27], s42 offen offset:3072 lds
    v_mfma_f32_16x16x32_bf16 v[208:211], a[252:255], a[76:79], v[208:211]
    s_waitcnt lgkmcnt(4)
    s_add_u32 m0, s56, 32768
    s_add_u32 s42, s58, 0
    v_mov_b32 v2, 0
    v_mov_b32 v3, 0
.p2align 3
L_oloop:
    v_mfma_f32_16x16x32_bf16 v[172:175], a[240:243], v[92:95], v[172:175]
    v_mfma_f32_16x16x32_bf16 v[176:179], a[240:243], v[96:99], v[176:179]
    s_add_u32 s43, s58, 7168
    buffer_load_dwordx4 v8, s[24:27], s42 offen offset:0 lds
    v_mfma_f32_16x16x32_bf16 v[180:183], a[240:243], v[100:103], v[180:183]
    v_mfma_f32_16x16x32_bf16 v[184:187], a[240:243], v[104:107], v[184:187]
    v_mfma_f32_16x16x32_bf16 v[188:191], a[240:243], v[108:111], v[188:191]
    s_waitcnt lgkmcnt(2)
    v_mfma_f32_16x16x32_bf16 v[192:195], a[244:247], v[92:95], v[192:195]
    s_add_u32 s42, s58, 14336
    buffer_load_dwordx4 v8, s[24:27], s43 offen offset:1024 lds
    v_mfma_f32_16x16x32_bf16 v[196:199], a[244:247], v[96:99], v[196:199]
    v_mfma_f32_16x16x32_bf16 v[200:203], a[244:247], v[100:103], v[200:203]
    v_mfma_f32_16x16x32_bf16 v[204:207], a[244:247], v[104:107], v[204:207]
    v_mfma_f32_16x16x32_bf16 v[208:211], a[244:247], v[108:111], v[208:211]
    s_waitcnt lgkmcnt(0)
    buffer_load_dwordx4 v8, s[24:27], s42 offen offset:2048 lds
    v_mfma_f32_16x16x32_bf16 v[172:175], a[248:251], v[112:115], v[172:175]
    s_add_u32 s43, s58, 21504
    ds_read_b64_tr_b16 a[252:253], v5 offset:4096
    ds_read_b64_tr_b16 a[254:255], v5 offset:6144
    v_mfma_f32_16x16x32_bf16 v[176:179], a[248:251], v[116:119], v[176:179]
    v_mfma_f32_16x16x32_bf16 v[180:183], a[248:251], v[120:123], v[180:183]
    v_mfma_f32_16x16x32_bf16 v[184:187], a[248:251], v[124:127], v[184:187]
    buffer_load_dwordx4 v8, s[24:27], s43 offen offset:3072 lds
    v_mfma_f32_16x16x32_bf16 v[188:191], a[248:251], v[128:131], v[188:191]
    s_waitcnt vmcnt(19)
    s_add_u32 m0, s56, 36864
    s_add_u32 s42, s58, 32768
    v_mfma_f32_16x16x32_bf16 v[52:55], v[12:15], v[20:23], v[52:55]
    ds_read_b64_tr_b16 a[240:241], v4 offset:8192
    ds_read_b64_tr_b16 a[242:243], v4 offset:10240
    v_mfma_f32_16x16x32_bf16 v[72:75], v[16:19], v[20:23], v[72:75]
    v_mfma_f32_16x16x32_bf16 v[56:59], v[12:15], v[24:27], v[56:59]
    s_add_u32 s43, s58, 39936
    buffer_load_dwordx4 v8, s[24:27], s42 offen offset:0 lds
    v_mfma_f32_16x16x32_bf16 v[76:79], v[16:19], v[24:27], v[76:79]
    v_mfma_f32_16x16x32_bf16 v[60:63], v[12:15], v[28:31], v[60:63]
    ds_read_b64_tr_b16 a[244:245], v5 offset:8192
    ds_read_b64_tr_b16 a[246:247], v5 offset:10240
    v_mfma_f32_16x16x32_bf16 v[80:83], v[16:19], v[28:31], v[80:83]
    v_mfma_f32_16x16x32_bf16 v[64:67], v[12:15], v[252:255], v[64:67]
    s_add_u32 s42, s58, 47104
    buffer_load_dwordx4 v8, s[24:27], s43 offen offset:1024 lds
    v_mfma_f32_16x16x32_bf16 v[84:87], v[16:19], v[252:255], v[84:87]
    v_mfma_f32_16x16x32_bf16 v[68:71], v[12:15], v[0:3], v[68:71]
    v_mfma_f32_16x16x32_bf16 v[88:91], v[16:19], v[0:3], v[88:91]
    s_waitcnt lgkmcnt(4)
    v_mfma_f32_16x16x32_bf16 v[192:195], a[252:255], v[112:115], v[192:195]
    s_add_u32 s43, s58, 54272
    buffer_load_dwordx4 v8, s[24:27], s42 offen offset:2048 lds
    v_mfma_f32_16x16x32_bf16 v[196:199], a[252:255], v[116:119], v[196:199]
    s_add_u32 s59, s59, 128
    ds_read_b64_tr_b16 a[248:249], v4 offset:12288
    ds_read_b64_tr_b16 a[250:251], v4 offset:14336
    v_mfma_f32_16x16x32_bf16 v[200:203], a[252:255], v[120:123], v[200:203]
    s_and_b32 s59, s59, 1023
    v_mfma_f32_16x16x32_bf16 v[204:207], a[252:255], v[124:127], v[204:207]
    s_add_u32 s57, s66, s59
    v_mfma_f32_16x16x32_bf16 v[208:211], a[252:255], v[128:131], v[208:211]
    s_waitcnt lgkmcnt(4)
    buffer_load_dwordx4 v8, s[24:27], s43 offen offset:3072 lds
    v_mfma_f32_16x16x32_bf16 v[172:175], a[240:243], v[132:135], v[172:175]
    s_add_u32 s58, s67, s59
    ds_read_b64_tr_b16 a[252:253], v5 offset:12288
    ds_read_b64_tr_b16 a[254:255], v5 offset:14336
    v_mfma_f32_16x16x32_bf16 v[176:179], a[240:243], v[136:139], v[176:179]
    v_mfma_f32_16x16x32_bf16 v[180:183], a[240:243], v[140:143], v[180:183]
    v_mfma_f32_16x16x32_bf16 v[184:187], a[240:243], v[144:147], v[184:187]
    v_mfma_f32_16x16x32_bf16 v[188:191], a[240:243], v[148:151], v[188:191]
    s_waitcnt lgkmcnt(4)
    v_mfma_f32_16x16x32_bf16 v[192:195], a[244:247], v[132:135], v[192:195]
    ds_read_b64_tr_b16 a[240:241], v6 offset:0
    ds_read_b64_tr_b16 a[242:243], v6 offset:2048
    v_mfma_f32_16x16x32_bf16 v[196:199], a[244:247], v[136:139], v[196:199]
    s_waitcnt vmcnt(8)
    v_readfirstlane_b32 s3, v51
    s_nop 1
    s_or_b32 s3, s3, s62
    s_and_b32 s3, s3, s50
    s_cmp_eq_u32 s3, s50
    s_cbranch_scc0 L_spinO1
L_goO1:
    v_mfma_f32_16x16x32_bf16 v[200:203], a[244:247], v[140:143], v[200:203]
    v_mfma_f32_16x16x32_bf16 v[204:207], a[244:247], v[144:147], v[204:207]
    buffer_load_dwordx4 v[20:23], v9, s[20:23], s39 offen offset:0 sc1
    v_mfma_f32_16x16x32_bf16 v[208:211], a[244:247], v[148:151], v[208:211]
    s_waitcnt lgkmcnt(4)
    v_mfma_f32_16x16x32_bf16 v[172:175], a[248:251], v[152:155], v[172:175]
    ds_read_b64_tr_b16 a[244:245], v7 offset:0
    ds_read_b64_tr_b16 a[246:247], v7 offset:2048
    v_mfma_f32_16x16x32_bf16 v[176:179], a[248:251], v[156:159], v[176:179]
    v_mfma_f32_16x16x32_bf16 v[180:183], a[248:251], v[160:163], v[180:183]
    v_mfma_f32_16x16x32_bf16 v[184:187], a[248:251], v[164:167], v[184:187]
    buffer_load_dwordx4 v[24:27], v9, s[20:23], s39 offen offset:1024 sc1
    v_mfma_f32_16x16x32_bf16 v[188:191], a[248:251], v[168:171], v[188:191]
    s_waitcnt lgkmcnt(4)
    v_mfma_f32_16x16x32_bf16 v[192:195], a[252:255], v[152:155], v[192:195]
    ds_read_b64_tr_b16 a[248:249], v6 offset:4096
    ds_read_b64_tr_b16 a[250:251], v6 offset:6144
    v_mfma_f32_16x16x32_bf16 v[196:199], a[252:255], v[156:159], v[196:199]
    v_mfma_f32_16x16x32_bf16 v[200:203], a[252:255], v[160:163], v[200:203]
    v_mfma_f32_16x16x32_bf16 v[204:207], a[252:255], v[164:167], v[204:207]
    buffer_load_dwordx4 v[28:31], v9, s[20:23], s39 offen offset:2048 sc1
    v_mfma_f32_16x16x32_bf16 v[208:211], a[252:255], v[168:171], v[208:211]
    s_waitcnt lgkmcnt(4)
    v_mfma_f32_16x16x32_bf16 v[172:175], a[240:243], a[80:83], v[172:175]
    ds_read_b64_tr_b16 a[252:253], v7 offset:4096
    ds_read_b64_tr_b16 a[254:255], v7 offset:6144
    v_mfma_f32_16x16x32_bf16 v[176:179], a[240:243], a[84:87], v[176:179]
    v_mfma_f32_16x16x32_bf16 v[180:183], a[240:243], a[88:91], v[180:183]
    v_mfma_f32_16x16x32_bf16 v[184:187], a[240:243], a[92:95], v[184:187]
    buffer_load_dwordx4 v[252:255], v9, s[20:23], s39 offen offset:3072 sc1
    v_mfma_f32_16x16x32_bf16 v[188:191], a[240:243], a[96:99], v[188:191]
    s_waitcnt lgkmcnt(4)
    v_mfma_f32_16x16x32_bf16 v[192:195], a[244:247], a[80:83], v[192:195]
    ds_read_b64_tr_b16 a[240:241], v6 offset:8192
    ds_read_b64_tr_b16 a[242:243], v6 offset:10240
    v_mfma_f32_16x16x32_bf16 v[196:199], a[244:247], a[84:87], v[196:199]
    v_mfma_f32_16x16x32_bf16 v[200:203], a[244:247], a[88:91], v[200:203]
    v_mfma_f32_16x16x32_bf16 v[204:207], a[244:247], a[92:95], v[204:207]
    buffer_load_dwordx4 v[0:3], v9, s[20:23], s40 offen offset:0 sc1
    v_mfma_f32_16x16x32_bf16 v[208:211], a[244:247], a[96:99], v[208:211]
    s_waitcnt lgkmcnt(4)
    v_mfma_f32_16x16x32_bf16 v[172:175], a[248:251], a[100:103], v[172:175]
    s_add_u32 s65, s65, 7
    ds_read_b64_tr_b16 a[244:245], v7 offset:8192
    ds_read_b64_tr_b16 a[246:247], v7 offset:10240
    v_mfma_f32_16x16x32_bf16 v[176:179], a[248:251], a[104:107], v[176:179]
    s_and_b32 s65, s65, 7
    v_mfma_f32_16x16x32_bf16 v[180:183], a[248:251], a[108:111], v[180:183]
    s_lshl_b32 s50, 1, s65
    v_mfma_f32_16x16x32_bf16 v[184:187], a[248:251], a[112:115], v[184:187]
    s_mul_i32 s39, s65, 20480
    v_mfma_f32_16x16x32_bf16 v[188:191], a[248:251], a[116:119], v[188:191]
    s_waitcnt lgkmcnt(4)
    s_add_u32 s39, s39, s53
    v_mfma_f32_16x16x32_bf16 v[192:195], a[252:255], a[100:103], v[192:195]
    s_add_u32 s40, s39, 4096
    ds_read_b64_tr_b16 a[248:249], v6 offset:12288
    ds_read_b64_tr_b16 a[250:251], v6 offset:14336
    v_mfma_f32_16x16x32_bf16 v[196:199], a[252:255], a[104:107], v[196:199]
    v_mfma_f32_16x16x32_bf16 v[200:203], a[252:255], a[108:111], v[200:203]
    v_mfma_f32_16x16x32_bf16 v[204:207], a[252:255], a[112:115], v[204:207]
    v_mfma_f32_16x16x32_bf16 v[208:211], a[252:255], a[116:119], v[208:211]
    s_waitcnt lgkmcnt(4)
    v_mfma_f32_16x16x32_bf16 v[172:175], a[240:243], a[120:123], v[172:175]
    ds_read_b64_tr_b16 a[252:253], v7 offset:12288
    ds_read_b64_tr_b16 a[254:255], v7 offset:14336
    v_mfma_f32_16x16x32_bf16 v[176:179], a[240:243], a[124:127], v[176:179]
    v_mfma_f32_16x16x32_bf16 v[180:183], a[240:243], a[128:131], v[180:183]
    v_mfma_f32_16x16x32_bf16 v[184:187], a[240:243], a[132:135], v[184:187]
    v_mfma_f32_16x16x32_bf16 v[188:191], a[240:243], a[136:139], v[188:191]
    s_waitcnt lgkmcnt(4)
    s_mov_b32 s26, s55
    v_add_u32 v4, 0xfffea000, v4
    v_add_u32 v5, 0xfffea000, v5
    v_mfma_f32_16x16x32_bf16 v[192:195], a[244:247], a[120:123], v[192:195]
    v_add_u32 v6, 0xfffea000, v6
    v_add_u32 v7, 0xfffea000, v7
    v_mfma_f32_16x16x32_bf16 v[196:199], a[244:247], a[124:127], v[196:199]
    v_mfma_f32_16x16x32_bf16 v[200:203], a[244:247], a[128:131], v[200:203]
    v_mfma_f32_16x16x32_bf16 v[204:207], a[244:247], a[132:135], v[204:207]
    v_mfma_f32_16x16x32_bf16 v[208:211], a[244:247], a[136:139], v[208:211]
    s_waitcnt lgkmcnt(2)
    v_mfma_f32_16x16x32_bf16 v[172:175], a[248:251], a[140:143], v[172:175]
    s_waitcnt vmcnt(13) lgkmcnt(0)
    s_barrier
    v_mfma_f32_16x16x32_bf16 v[176:179], a[248:251], a[144:147], v[176:179]
    buffer_atomic_or v11, v10, s[16:19], s38 offen sc1
    v_mfma_f32_16x16x32_bf16 v[180:183], a[248:251], a[148:151], v[180:183]
    ds_read_b64_tr_b16 a[240:241], v4 offset:0
    ds_read_b64_tr_b16 a[242:243], v4 offset:2048
    v_mfma_f32_16x16x32_bf16 v[184:187], a[248:251], a[152:155], v[184:187]
    ds_read_b64_tr_b16 a[244:245], v5 offset:0
    ds_read_b64_tr_b16 a[246:247], v5 offset:2048
    v_mfma_f32_16x16x32_bf16 v[188:191], a[248:251], a[156:159], v[188:191]
    v_mfma_f32_16x16x32_bf16 v[192:195], a[252:255], a[140:143], v[192:195]
    ds_read_b64_tr_b16 a[248:249], v4 offset:4096
    ds_read_b64_tr_b16 a[250:251], v4 offset:6144
    v_mfma_f32_16x16x32_bf16 v[196:199], a[252:255], a[144:147], v[196:199]
    v_mfma_f32_16x16x32_bf16 v[200:203], a[252:255], a[148:151], v[200:203]
    v_mfma_f32_16x16x32_bf16 v[204:207], a[252:255], a[152:155], v[204:207]
    s_add_u32 m0, s56, 122880
    s_add_u32 s42, s57, 0
    v_mfma_f32_16x16x32_bf16 v[208:211], a[252:255], a[156:159], v[208:211]
    s_waitcnt lgkmcnt(4)
    v_mfma_f32_16x16x32_bf16 v[212:215], a[240:243], a[160:163], 0
    ds_read_b64_tr_b16 a[252:253], v5 offset:4096
    ds_read_b64_tr_b16 a[254:255], v5 offset:6144
    v_mfma_f32_16x16x32_bf16 v[216:219], a[240:243], a[164:167], 0
    s_add_u32 s43, s57, 7168
    buffer_load_dwordx4 v8, s[24:27], s42 offen offset:0 lds
    v_mfma_f32_16x16x32_bf16 v[220:223], a[240:243], a[168:171], 0
    v_mfma_f32_16x16x32_bf16 v[224:227], a[240:243], a[172:175], 0
    v_mfma_f32_16x16x32_bf16 v[228:231], a[240:243], a[176:179], 0
    s_waitcnt lgkmcnt(4)
    v_cvt_pk_bf16_f32 v32, v172, v173
    v_cvt_pk_bf16_f32 v33, v174, v175
    v_mfma_f32_16x16x32_bf16 v[232:235], a[244:247], a[160:163], 0
    ds_read_b64_tr_b16 a[240:241], v4 offset:8192
    ds_read_b64_tr_b16 a[242:243], v4 offset:10240
    v_mfma_f32_16x16x32_bf16 v[236:239], a[244:247], a[164:167], 0
    v_cvt_pk_bf16_f32 v36, v176, v177
    v_cvt_pk_bf16_f32 v37, v178, v179
    v_mfma_f32_16x16x32_bf16 v[240:243], a[244:247], a[168:171], 0
    s_add_u32 s42, s57, 14336
    buffer_load_dwordx4 v8, s[24:27], s43 offen offset:1024 lds
    v_mfma_f32_16x16x32_bf16 v[244:247], a[244:247], a[172:175], 0
    v_cvt_pk_bf16_f32 v40, v180, v181
    v_cvt_pk_bf16_f32 v41, v182, v183
    v_mfma_f32_16x16x32_bf16 v[248:251], a[244:247], a[176:179], 0
    s_waitcnt lgkmcnt(4)
    v_cvt_pk_bf16_f32 v44, v184, v185
    v_cvt_pk_bf16_f32 v45, v186, v187
    v_mfma_f32_16x16x32_bf16 v[212:215], a[248:251], a[180:183], v[212:215]
    ds_read_b64_tr_b16 a[244:245], v5 offset:8192
    ds_read_b64_tr_b16 a[246:247], v5 offset:10240
    v_mfma_f32_16x16x32_bf16 v[216:219], a[248:251], a[184:187], v[216:219]
    v_cvt_pk_bf16_f32 v48, v188, v189
    v_cvt_pk_bf16_f32 v49, v190, v191
    v_mfma_f32_16x16x32_bf16 v[220:223], a[248:251], a[188:191], v[220:223]
    v_cvt_pk_bf16_f32 v34, v192, v193
    v_cvt_pk_bf16_f32 v35, v194, v195
    v_mfma_f32_16x16x32_bf16 v[224:227], a[248:251], a[192:195], v[224:227]
    v_cvt_pk_bf16_f32 v38, v196, v197
    v_cvt_pk_bf16_f32 v39, v198, v199
    v_mfma_f32_16x16x32_bf16 v[228:231], a[248:251], a[196:199], v[228:231]
    s_waitcnt lgkmcnt(4)
    buffer_load_dwordx4 v8, s[24:27], s42 offen offset:2048 lds
    v_mfma_f32_16x16x32_bf16 v[232:235], a[252:255], a[180:183], v[232:235]
    s_add_u32 s43, s57, 21504
    ds_read_b64_tr_b16 a[248:249], v4 offset:12288
    ds_read_b64_tr_b16 a[250:251], v4 offset:14336
    v_mfma_f32_16x16x32_bf16 v[236:239], a[252:255], a[184:187], v[236:239]
    buffer_store_dwordx4 v[32:35], v9, s[28:31], s60 offen offset:0 sc1
    v_mfma_f32_16x16x32_bf16 v[240:243], a[252:255], a[188:191], v[240:243]
    v_cvt_pk_bf16_f32 v42, v200, v201
    v_cvt_pk_bf16_f32 v43, v202, v203
    v_mfma_f32_16x16x32_bf16 v[244:247], a[252:255], a[192:195], v[244:247]
    v_cvt_pk_bf16_f32 v46, v204, v205
    v_cvt_pk_bf16_f32 v47, v206, v207
    v_mfma_f32_16x16x32_bf16 v[248:251], a[252:255], a[196:199], v[248:251]
    s_waitcnt lgkmcnt(4)
    v_cvt_pk_bf16_f32 v50, v208, v209
    v_cvt_pk_bf16_f32 v51, v210, v211
    v_mfma_f32_16x16x32_bf16 v[212:215], a[240:243], a[200:203], v[212:215]
    ds_read_b64_tr_b16 a[252:253], v5 offset:12288
    ds_read_b64_tr_b16 a[254:255], v5 offset:14336
    v_mfma_f32_16x16x32_bf16 v[216:219], a[240:243], a[204:207], v[216:219]
    buffer_load_dwordx4 v8, s[24:27], s43 offen offset:3072 lds
    v_mfma_f32_16x16x32_bf16 v[220:223], a[240:243], a[208:211], v[220:223]
    s_add_u32 m0, s56, 126976
    s_add_u32 s42, s57, 32768
    v_mfma_f32_16x16x32_bf16 v[224:227], a[240:243], a[212:215], v[224:227]
    buffer_store_dwordx4 v[36:39], v9, s[28:31], s60 offen offset:1024 sc1
    v_mfma_f32_16x16x32_bf16 v[228:231], a[240:243], a[216:219], v[228:231]
    s_waitcnt lgkmcnt(4)
    v_mfma_f32_16x16x32_bf16 v[232:235], a[244:247], a[200:203], v[232:235]
    ds_read_b64_tr_b16 a[240:241], v6 offset:0
    ds_read_b64_tr_b16 a[242:243], v6 offset:2048
    v_mfma_f32_16x16x32_bf16 v[236:239], a[244:247], a[204:207], v[236:239]
    v_mfma_f32_16x16x32_bf16 v[240:243], a[244:247], a[208:211], v[240:243]
    v_mfma_f32_16x16x32_bf16 v[244:247], a[244:247], a[212:215], v[244:247]
    s_add_u32 s43, s57, 39936
    buffer_load_dwordx4 v8, s[24:27], s42 offen offset:0 lds
    v_mfma_f32_16x16x32_bf16 v[248:251], a[244:247], a[216:219], v[248:251]
    s_waitcnt lgkmcnt(4)
    v_mfma_f32_16x16x32_bf16 v[212:215], a[248:251], a[220:223], v[212:215]
    ds_read_b64_tr_b16 a[244:245], v7 offset:0
    ds_read_b64_tr_b16 a[246:247], v7 offset:2048
    v_mfma_f32_16x16x32_bf16 v[216:219], a[248:251], a[224:227], v[216:219]
    buffer_store_dwordx4 v[40:43], v9, s[28:31], s60 offen offset:2048 sc1
    v_mfma_f32_16x16x32_bf16 v[220:223], a[248:251], a[228:231], v[220:223]
    v_mfma_f32_16x16x32_bf16 v[224:227], a[248:251], a[232:235], v[224:227]
    v_mfma_f32_16x16x32_bf16 v[228:231], a[248:251], a[236:239], v[228:231]
    s_waitcnt lgkmcnt(4)
    v_mfma_f32_16x16x32_bf16 v[232:235], a[252:255], a[220:223], v[232:235]
    ds_read_b64_tr_b16 a[248:249], v6 offset:4096
    ds_read_b64_tr_b16 a[250:251], v6 offset:6144
    v_mfma_f32_16x16x32_bf16 v[236:239], a[252:255], a[224:227], v[236:239]
    s_add_u32 s42, s57, 47104
    buffer_load_dwordx4 v8, s[24:27], s43 offen offset:1024 lds
    v_mfma_f32_16x16x32_bf16 v[240:243], a[252:255], a[228:231], v[240:243]
    v_mfma_f32_16x16x32_bf16 v[244:247], a[252:255], a[232:235], v[244:247]
    buffer_store_dwordx4 v[44:47], v9, s[28:31], s60 offen offset:3072 sc1
    v_mfma_f32_16x16x32_bf16 v[248:251], a[252:255], a[236:239], v[248:251]
    s_waitcnt lgkmcnt(4)
    v_mfma_f32_16x16x32_bf16 v[212:215], a[240:243], a[0:3], v[212:215]
    ds_read_b64_tr_b16 a[252:253], v7 offset:4096
    ds_read_b64_tr_b16 a[254:255], v7 offset:6144
    v_mfma_f32_16x16x32_bf16 v[216:219], a[240:243], a[4:7], v[216:219]
    v_mfma_f32_16x16x32_bf16 v[220:223], a[240:243], a[8:11], v[220:223]
    s_add_u32 s43, s57, 54272
    buffer_load_dwordx4 v8, s[24:27], s42 offen offset:2048 lds
    v_mfma_f32_16x16x32_bf16 v[224:227], a[240:243], a[12:15], v[224:227]
    v_mfma_f32_16x16x32_bf16 v[228:231], a[240:243], a[16:19], v[228:231]
    s_waitcnt lgkmcnt(4)
    v_mfma_f32_16x16x32_bf16 v[232:235], a[244:247], a[0:3], v[232:235]
    ds_read_b64_tr_b16 a[240:241], v6 offset:8192
    ds_read_b64_tr_b16 a[242:243], v6 offset:10240
    v_mfma_f32_16x16x32_bf16 v[236:239], a[244:247], a[4:7], v[236:239]
    buffer_store_dwordx4 v[48:51], v9, s[28:31], s37 offen offset:0 sc1
    v_mfma_f32_16x16x32_bf16 v[240:243], a[244:247], a[8:11], v[240:243]
    v_mfma_f32_16x16x32_bf16 v[244:247], a[244:247], a[12:15], v[244:247]
    v_mfma_f32_16x16x32_bf16 v[248:251], a[244:247], a[16:19], v[248:251]
    s_waitcnt lgkmcnt(4)
    buffer_load_dwordx4 v8, s[24:27], s43 offen offset:3072 lds
    v_mfma_f32_16x16x32_bf16 v[212:215], a[248:251], a[20:23], v[212:215]
    ds_read_b64_tr_b16 a[244:245], v7 offset:8192
    ds_read_b64_tr_b16 a[246:247], v7 offset:10240
    v_mfma_f32_16x16x32_bf16 v[216:219], a[248:251], a[24:27], v[216:219]
    v_mfma_f32_16x16x32_bf16 v[220:223], a[248:251], a[28:31], v[220:223]
    v_mfma_f32_16x16x32_bf16 v[224:227], a[248:251], a[32:35], v[224:227]
    buffer_load_dword v51, off, s[16:19], s41 sc1
    v_mfma_f32_16x16x32_bf16 v[228:231], a[248:251], a[36:39], v[228:231]
    s_waitcnt lgkmcnt(4)
    s_lshl_b32 s38, s64, 7
    v_mfma_f32_16x16x32_bf16 v[232:235], a[252:255], a[20:23], v[232:235]
    s_add_u32 s38, s38, s54
    ds_read_b64_tr_b16 a[248:249], v6 offset:12288
    ds_read_b64_tr_b16 a[250:251], v6 offset:14336
    v_mfma_f32_16x16x32_bf16 v[236:239], a[252:255], a[24:27], v[236:239]
    s_add_u32 s64, s64, 1
    v_mfma_f32_16x16x32_bf16 v[240:243], a[252:255], a[28:31], v[240:243]
    s_and_b32 s64, s64, 7
    v_mfma_f32_16x16x32_bf16 v[244:247], a[252:255], a[32:35], v[244:247]
    s_mul_i32 s60, s64, 163840
    v_mfma_f32_16x16x32_bf16 v[248:251], a[252:255], a[36:39], v[248:251]
    s_waitcnt lgkmcnt(4)
    s_add_u32 s60, s60, s51
    v_mfma_f32_16x16x32_bf16 v[212:215], a[240:243], a[40:43], v[212:215]
    s_add_u32 s60, s60, s52
    ds_read_b64_tr_b16 a[252:253], v7 offset:12288
    ds_read_b64_tr_b16 a[254:255], v7 offset:14336
    v_mfma_f32_16x16x32_bf16 v[216:219], a[240:243], a[44:47], v[216:219]
    s_add_u32 s37, s60, 4096
    v_mfma_f32_16x16x32_bf16 v[220:223], a[240:243], a[48:51], v[220:223]
    v_mfma_f32_16x16x32_bf16 v[224:227], a[240:243], a[52:55], v[224:227]
    v_mfma_f32_16x16x32_bf16 v[228:231], a[240:243], a[56:59], v[228:231]
    s_waitcnt lgkmcnt(4)
    v_mfma_f32_16x16x32_bf16 v[232:235], a[244:247], a[40:43], v[232:235]
    v_mfma_f32_16x16x32_bf16 v[236:239], a[244:247], a[44:47], v[236:239]
    v_mfma_f32_16x16x32_bf16 v[240:243], a[244:247], a[48:51], v[240:243]
    v_mfma_f32_16x16x32_bf16 v[244:247], a[244:247], a[52:55], v[244:247]
    v_mfma_f32_16x16x32_bf16 v[248:251], a[244:247], a[56:59], v[248:251]
    s_waitcnt lgkmcnt(2)
    v_mfma_f32_16x16x32_bf16 v[212:215], a[248:251], a[60:63], v[212:215]
    s_waitcnt vmcnt(20) lgkmcnt(0)
    s_barrier
    v_mfma_f32_16x16x32_bf16 v[216:219], a[248:251], a[64:67], v[216:219]
    ds_read_b64_tr_b16 a[240:241], v4 offset:32768
    ds_read_b64_tr_b16 a[242:243], v4 offset:34816
    v_mfma_f32_16x16x32_bf16 v[220:223], a[248:251], a[68:71], v[220:223]
    ds_read_b64_tr_b16 a[244:245], v5 offset:32768
    ds_read_b64_tr_b16 a[246:247], v5 offset:34816
    v_mfma_f32_16x16x32_bf16 v[224:227], a[248:251], a[72:75], v[224:227]
    v_mfma_f32_16x16x32_bf16 v[228:231], a[248:251], a[76:79], v[228:231]
    v_mfma_f32_16x16x32_bf16 v[232:235], a[252:255], a[60:63], v[232:235]
    ds_read_b64_tr_b16 a[248:249], v4 offset:36864
    ds_read_b64_tr_b16 a[250:251], v4 offset:38912
    v_mfma_f32_16x16x32_bf16 v[236:239], a[252:255], a[64:67], v[236:239]
    v_mfma_f32_16x16x32_bf16 v[240:243], a[252:255], a[68:71], v[240:243]
    v_mfma_f32_16x16x32_bf16 v[244:247], a[252:255], a[72:75], v[244:247]
    v_mfma_f32_16x16x32_bf16 v[248:251], a[252:255], a[76:79], v[248:251]
    s_waitcnt lgkmcnt(4)
    s_add_u32 m0, s56, 90112
    s_add_u32 s42, s58, 0
    v_mfma_f32_16x16x32_bf16 v[212:215], a[240:243], v[92:95], v[212:215]
    v_mfma_f32_16x16x32_bf16 v[216:219], a[240:243], v[96:99], v[216:219]
    s_add_u32 s43, s58, 7168
    buffer_load_dwordx4 v8, s[24:27], s42 offen offset:0 lds
    v_mfma_f32_16x16x32_bf16 v[220:223], a[240:243], v[100:103], v[220:223]
    v_mfma_f32_16x16x32_bf16 v[224:227], a[240:243], v[104:107], v[224:227]
    v_mfma_f32_16x16x32_bf16 v[228:231], a[240:243], v[108:111], v[228:231]
    s_waitcnt lgkmcnt(2)
    v_mfma_f32_16x16x32_bf16 v[232:235], a[244:247], v[92:95], v[232:235]
    s_add_u32 s42, s58, 14336
    buffer_load_dwordx4 v8, s[24:27], s43 offen offset:1024 lds
    v_mfma_f32_16x16x32_bf16 v[236:239], a[244:247], v[96:99], v[236:239]
    v_mfma_f32_16x16x32_bf16 v[240:243], a[244:247], v[100:103], v[240:243]
    v_mfma_f32_16x16x32_bf16 v[244:247], a[244:247], v[104:107], v[244:247]
    v_mfma_f32_16x16x32_bf16 v[248:251], a[244:247], v[108:111], v[248:251]
    s_waitcnt lgkmcnt(0)
    buffer_load_dwordx4 v8, s[24:27], s42 offen offset:2048 lds
    v_mfma_f32_16x16x32_bf16 v[212:215], a[248:251], v[112:115], v[212:215]
    s_add_u32 s43, s58, 21504
    ds_read_b64_tr_b16 a[252:253], v5 offset:36864
    ds_read_b64_tr_b16 a[254:255], v5 offset:38912
    v_mfma_f32_16x16x32_bf16 v[216:219], a[248:251], v[116:119], v[216:219]
    v_mfma_f32_16x16x32_bf16 v[220:223], a[248:251], v[120:123], v[220:223]
    v_mfma_f32_16x16x32_bf16 v[224:227], a[248:251], v[124:127], v[224:227]
    buffer_load_dwordx4 v8, s[24:27], s43 offen offset:3072 lds
    v_mfma_f32_16x16x32_bf16 v[228:231], a[248:251], v[128:131], v[228:231]
    s_waitcnt vmcnt(19)
    s_add_u32 m0, s56, 94208
    s_add_u32 s42, s58, 32768
    v_mfma_f32_16x16x32_bf16 v[52:55], v[12:15], v[20:23], v[52:55]
    ds_read_b64_tr_b16 a[240:241], v4 offset:40960
    ds_read_b64_tr_b16 a[242:243], v4 offset:43008
    v_mfma_f32_16x16x32_bf16 v[72:75], v[16:19], v[20:23], v[72:75]
    v_mfma_f32_16x16x32_bf16 v[56:59], v[12:15], v[24:27], v[56:59]
    s_add_u32 s43, s58, 39936
    buffer_load_dwordx4 v8, s[24:27], s42 offen offset:0 lds
    v_mfma_f32_16x16x32_bf16 v[76:79], v[16:19], v[24:27], v[76:79]
    v_mfma_f32_16x16x32_bf16 v[60:63], v[12:15], v[28:31], v[60:63]
    ds_read_b64_tr_b16 a[244:245], v5 offset:40960
    ds_read_b64_tr_b16 a[246:247], v5 offset:43008
    v_mfma_f32_16x16x32_bf16 v[80:83], v[16:19], v[28:31], v[80:83]
    v_mfma_f32_16x16x32_bf16 v[64:67], v[12:15], v[252:255], v[64:67]
    s_add_u32 s42, s58, 47104
    buffer_load_dwordx4 v8, s[24:27], s43 offen offset:1024 lds
    v_mfma_f32_16x16x32_bf16 v[84:87], v[16:19], v[252:255], v[84:87]
    v_mfma_f32_16x16x32_bf16 v[68:71], v[12:15], v[0:3], v[68:71]
    v_mfma_f32_16x16x32_bf16 v[88:91], v[16:19], v[0:3], v[88:91]
    s_waitcnt lgkmcnt(4)
    v_mfma_f32_16x16x32_bf16 v[232:235], a[252:255], v[112:115], v[232:235]
    s_add_u32 s43, s58, 54272
    buffer_load_dwordx4 v8, s[24:27], s42 offen offset:2048 lds
    v_mfma_f32_16x16x32_bf16 v[236:239], a[252:255], v[116:119], v[236:239]
    s_add_u32 s59, s59, 128
    ds_read_b64_tr_b16 a[248:249], v4 offset:45056
    ds_read_b64_tr_b16 a[250:251], v4 offset:47104
    v_mfma_f32_16x16x32_bf16 v[240:243], a[252:255], v[120:123], v[240:243]
    s_and_b32 s59, s59, 1023
    v_mfma_f32_16x16x32_bf16 v[244:247], a[252:255], v[124:127], v[244:247]
    s_add_u32 s57, s66, s59
    v_mfma_f32_16x16x32_bf16 v[248:251], a[252:255], v[128:131], v[248:251]
    s_waitcnt lgkmcnt(4)
    buffer_load_dwordx4 v8, s[24:27], s43 offen offset:3072 lds
    v_mfma_f32_16x16x32_bf16 v[212:215], a[240:243], v[132:135], v[212:215]
    s_add_u32 s58, s67, s59
    ds_read_b64_tr_b16 a[252:253], v5 offset:45056
    ds_read_b64_tr_b16 a[254:255], v5 offset:47104
    v_mfma_f32_16x16x32_bf16 v[216:219], a[240:243], v[136:139], v[216:219]
    v_mfma_f32_16x16x32_bf16 v[220:223], a[240:243], v[140:143], v[220:223]
    v_mfma_f32_16x16x32_bf16 v[224:227], a[240:243], v[144:147], v[224:227]
    v_mfma_f32_16x16x32_bf16 v[228:231], a[240:243], v[148:151], v[228:231]
    s_waitcnt lgkmcnt(4)
    v_mfma_f32_16x16x32_bf16 v[232:235], a[244:247], v[132:135], v[232:235]
    ds_read_b64_tr_b16 a[240:241], v6 offset:32768
    ds_read_b64_tr_b16 a[242:243], v6 offset:34816
    v_mfma_f32_16x16x32_bf16 v[236:239], a[244:247], v[136:139], v[236:239]
    s_waitcnt vmcnt(8)
    v_readfirstlane_b32 s3, v51
    s_nop 1
    s_or_b32 s3, s3, s62
    s_and_b32 s3, s3, s50
    s_cmp_eq_u32 s3, s50
    s_cbranch_scc0 L_spinO3
L_goO3:
    v_mfma_f32_16x16x32_bf16 v[240:243], a[244:247], v[140:143], v[240:243]
    v_mfma_f32_16x16x32_bf16 v[244:247], a[244:247], v[144:147], v[244:247]
    buffer_load_dwordx4 v[20:23], v9, s[20:23], s39 offen offset:0 sc1
    v_mfma_f32_16x16x32_bf16 v[248:251], a[244:247], v[148:151], v[248:251]
    s_waitcnt lgkmcnt(4)
    v_mfma_f32_16x16x32_bf16 v[212:215], a[248:251], v[152:155], v[212:215]
    ds_read_b64_tr_b16 a[244:245], v7 offset:32768
    ds_read_b64_tr_b16 a[246:247], v7 offset:34816
    v_mfma_f32_16x16x32_bf16 v[216:219], a[248:251], v[156:159], v[216:219]
    v_mfma_f32_16x16x32_bf16 v[220:223], a[248:251], v[160:163], v[220:223]
    v_mfma_f32_16x16x32_bf16 v[224:227], a[248:251], v[164:167], v[224:227]
    buffer_load_dwordx4 v[24:27], v9, s[20:23], s39 offen offset:1024 sc1
    v_mfma_f32_16x16x32_bf16 v[228:231], a[248:251], v[168:171], v[228:231]
    s_waitcnt lgkmcnt(4)
    v_mfma_f32_16x16x32_bf16 v[232:235], a[252:255], v[152:155], v[232:235]
    ds_read_b64_tr_b16 a[248:249], v6 offset:36864
    ds_read_b64_tr_b16 a[250:251], v6 offset:38912
    v_mfma_f32_16x16x32_bf16 v[236:239], a[252:255], v[156:159], v[236:239]
    v_mfma_f32_16x16x32_bf16 v[240:243], a[252:255], v[160:163], v[240:243]
    v_mfma_f32_16x16x32_bf16 v[244:247], a[252:255], v[164:167], v[244:247]
    buffer_load_dwordx4 v[28:31], v9, s[20:23], s39 offen offset:2048 sc1
    v_mfma_f32_16x16x32_bf16 v[248:251], a[252:255], v[168:171], v[248:251]
    s_waitcnt lgkmcnt(4)
    v_mfma_f32_16x16x32_bf16 v[212:215], a[240:243], a[80:83], v[212:215]
    ds_read_b64_tr_b16 a[252:253], v7 offset:36864
    ds_read_b64_tr_b16 a[254:255], v7 offset:38912
    v_mfma_f32_16x16x32_bf16 v[216:219], a[240:243], a[84:87], v[216:219]
    v_mfma_f32_16x16x32_bf16 v[220:223], a[240:243], a[88:91], v[220:223]
    v_mfma_f32_16x16x32_bf16 v[224:227], a[240:243], a[92:95], v[224:227]
    buffer_load_dwordx4 v[252:255], v9, s[20:23], s39 offen offset:3072 sc1
    v_mfma_f32_16x16x32_bf16 v[228:231], a[240:243], a[96:99], v[228:231]
    s_waitcnt lgkmcnt(4)
    v_mfma_f32_16x16x32_bf16 v[232:235], a[244:247], a[80:83], v[232:235]
    ds_read_b64_tr_b16 a[240:241], v6 offset:40960
    ds_read_b64_tr_b16 a[242:243], v6 offset:43008
    v_mfma_f32_16x16x32_bf16 v[236:239], a[244:247], a[84:87], v[236:239]
    v_mfma_f32_16x16x32_bf16 v[240:243], a[244:247], a[88:91], v[240:243]
    v_mfma_f32_16x16x32_bf16 v[244:247], a[244:247], a[92:95], v[244:247]
    buffer_load_dwordx4 v[0:3], v9, s[20:23], s40 offen offset:0 sc1
    v_mfma_f32_16x16x32_bf16 v[248:251], a[244:247], a[96:99], v[248:251]
    s_waitcnt lgkmcnt(4)
    v_mfma_f32_16x16x32_bf16 v[212:215], a[248:251], a[100:103], v[212:215]
    s_add_u32 s65, s65, 7
    ds_read_b64_tr_b16 a[244:245], v7 offset:40960
    ds_read_b64_tr_b16 a[246:247], v7 offset:43008
    v_mfma_f32_16x16x32_bf16 v[216:219], a[248:251], a[104:107], v[216:219]
    s_and_b32 s65, s65, 7
    v_mfma_f32_16x16x32_bf16 v[220:223], a[248:251], a[108:111], v[220:223]
    s_lshl_b32 s50, 1, s65
    v_mfma_f32_16x16x32_bf16 v[224:227], a[248:251], a[112:115], v[224:227]
    s_mul_i32 s39, s65, 20480
    v_mfma_f32_16x16x32_bf16 v[228:231], a[248:251], a[116:119], v[228:231]
    s_waitcnt lgkmcnt(4)
    s_add_u32 s39, s39, s53
    v_mfma_f32_16x16x32_bf16 v[232:235], a[252:255], a[100:103], v[232:235]
    s_add_u32 s40, s39, 4096
    ds_read_b64_tr_b16 a[248:249], v6 offset:45056
    ds_read_b64_tr_b16 a[250:251], v6 offset:47104
    v_mfma_f32_16x16x32_bf16 v[236:239], a[252:255], a[104:107], v[236:239]
    v_mfma_f32_16x16x32_bf16 v[240:243], a[252:255], a[108:111], v[240:243]
    v_mfma_f32_16x16x32_bf16 v[244:247], a[252:255], a[112:115], v[244:247]
    v_mfma_f32_16x16x32_bf16 v[248:251], a[252:255], a[116:119], v[248:251]
    s_waitcnt lgkmcnt(4)
    v_mfma_f32_16x16x32_bf16 v[212:215], a[240:243], a[120:123], v[212:215]
    ds_read_b64_tr_b16 a[252:253], v7 offset:45056
    ds_read_b64_tr_b16 a[254:255], v7 offset:47104
    v_mfma_f32_16x16x32_bf16 v[216:219], a[240:243], a[124:127], v[216:219]
    v_mfma_f32_16x16x32_bf16 v[220:223], a[240:243], a[128:131], v[220:223]
    s_mov_b32 s22, 1310720
    v_mfma_f32_16x16x32_bf16 v[224:227], a[240:243], a[132:135], v[224:227]
    v_mfma_f32_16x16x32_bf16 v[228:231], a[240:243], a[136:139], v[228:231]
    s_waitcnt lgkmcnt(4)
    v_add_u32 v4, 0x16000, v4
    v_add_u32 v5, 0x16000, v5
    v_mfma_f32_16x16x32_bf16 v[232:235], a[244:247], a[120:123], v[232:235]
    v_add_u32 v6, 0x16000, v6
    v_add_u32 v7, 0x16000, v7
    v_mfma_f32_16x16x32_bf16 v[236:239], a[244:247], a[124:127], v[236:239]
    v_mfma_f32_16x16x32_bf16 v[240:243], a[244:247], a[128:131], v[240:243]
    v_mfma_f32_16x16x32_bf16 v[244:247], a[244:247], a[132:135], v[244:247]
    v_mfma_f32_16x16x32_bf16 v[248:251], a[244:247], a[136:139], v[248:251]
    s_waitcnt lgkmcnt(2)
    v_mfma_f32_16x16x32_bf16 v[212:215], a[248:251], a[140:143], v[212:215]
    s_waitcnt lgkmcnt(0)
    s_barrier
    v_mfma_f32_16x16x32_bf16 v[216:219], a[248:251], a[144:147], v[216:219]
    buffer_atomic_or v11, v10, s[16:19], s38 offen sc1
    v_mfma_f32_16x16x32_bf16 v[220:223], a[248:251], a[148:151], v[220:223]
    ds_read_b64_tr_b16 a[240:241], v4 offset:32768
    ds_read_b64_tr_b16 a[242:243], v4 offset:34816
    v_mfma_f32_16x16x32_bf16 v[224:227], a[248:251], a[152:155], v[224:227]
    ds_read_b64_tr_b16 a[244:245], v5 offset:32768
    ds_read_b64_tr_b16 a[246:247], v5 offset:34816
    v_mfma_f32_16x16x32_bf16 v[228:231], a[248:251], a[156:159], v[228:231]
    v_mfma_f32_16x16x32_bf16 v[232:235], a[252:255], a[140:143], v[232:235]
    ds_read_b64_tr_b16 a[248:249], v4 offset:36864
    ds_read_b64_tr_b16 a[250:251], v4 offset:38912
    v_mfma_f32_16x16x32_bf16 v[236:239], a[252:255], a[144:147], v[236:239]
    v_mfma_f32_16x16x32_bf16 v[240:243], a[252:255], a[148:151], v[240:243]
    v_mfma_f32_16x16x32_bf16 v[244:247], a[252:255], a[152:155], v[244:247]
    s_add_u32 m0, s56, 0
    s_add_u32 s42, s57, 0
    v_mfma_f32_16x16x32_bf16 v[248:251], a[252:255], a[156:159], v[248:251]
    s_waitcnt lgkmcnt(4)
    s_cmp_eq_u32 s36, 3
    s_cbranch_scc1 L_otail
    v_mfma_f32_16x16x32_bf16 v[172:175], a[240:243], a[160:163], 0
    ds_read_b64_tr_b16 a[252:253], v5 offset:36864
    ds_read_b64_tr_b16 a[254:255], v5 offset:38912
    v_mfma_f32_16x16x32_bf16 v[176:179], a[240:243], a[164:167], 0
    s_add_u32 s43, s57, 7168
    buffer_load_dwordx4 v8, s[24:27], s42 offen offset:0 lds
    v_mfma_f32_16x16x32_bf16 v[180:183], a[240:243], a[168:171], 0
    v_mfma_f32_16x16x32_bf16 v[184:187], a[240:243], a[172:175], 0
    v_mfma_f32_16x16x32_bf16 v[188:191], a[240:243], a[176:179], 0
    s_waitcnt lgkmcnt(4)
    v_cvt_pk_bf16_f32 v32, v212, v213
    v_cvt_pk_bf16_f32 v33, v214, v215
    v_mfma_f32_16x16x32_bf16 v[192:195], a[244:247], a[160:163], 0
    ds_read_b64_tr_b16 a[240:241], v4 offset:40960
    ds_read_b64_tr_b16 a[242:243], v4 offset:43008
    v_mfma_f32_16x16x32_bf16 v[196:199], a[244:247], a[164:167], 0
    v_cvt_pk_bf16_f32 v36, v216, v217
    v_cvt_pk_bf16_f32 v37, v218, v219
    v_mfma_f32_16x16x32_bf16 v[200:203], a[244:247], a[168:171], 0
    s_add_u32 s42, s57, 14336
    buffer_load_dwordx4 v8, s[24:27], s43 offen offset:1024 lds
    v_mfma_f32_16x16x32_bf16 v[204:207], a[244:247], a[172:175], 0
    v_cvt_pk_bf16_f32 v40, v220, v221
    v_cvt_pk_bf16_f32 v41, v222, v223
    v_mfma_f32_16x16x32_bf16 v[208:211], a[244:247], a[176:179], 0
    s_waitcnt lgkmcnt(4)
    v_cvt_pk_bf16_f32 v44, v224, v225
    v_cvt_pk_bf16_f32 v45, v226, v227
    v_mfma_f32_16x16x32_bf16 v[172:175], a[248:251], a[180:183], v[172:175]
    ds_read_b64_tr_b16 a[244:245], v5 offset:40960
    ds_read_b64_tr_b16 a[246:247], v5 offset:43008
    v_mfma_f32_16x16x32_bf16 v[176:179], a[248:251], a[184:187], v[176:179]
    v_cvt_pk_bf16_f32 v48, v228, v229
    v_cvt_pk_bf16_f32 v49, v230, v231
    v_mfma_f32_16x16x32_bf16 v[180:183], a[248:251], a[188:191], v[180:183]
    v_cvt_pk_bf16_f32 v34, v232, v233
    v_cvt_pk_bf16_f32 v35, v234, v235
    v_mfma_f32_16x16x32_bf16 v[184:187], a[248:251], a[192:195], v[184:187]
    v_cvt_pk_bf16_f32 v38, v236, v237
    v_cvt_pk_bf16_f32 v39, v238, v239
    v_mfma_f32_16x16x32_bf16 v[188:191], a[248:251], a[196:199], v[188:191]
    s_waitcnt lgkmcnt(4)
    buffer_load_dwordx4 v8, s[24:27], s42 offen offset:2048 lds
    v_mfma_f32_16x16x32_bf16 v[192:195], a[252:255], a[180:183], v[192:195]
    s_add_u32 s43, s57, 21504
    ds_read_b64_tr_b16 a[248:249], v4 offset:45056
    ds_read_b64_tr_b16 a[250:251], v4 offset:47104
    v_mfma_f32_16x16x32_bf16 v[196:199], a[252:255], a[184:187], v[196:199]
    buffer_store_dwordx4 v[32:35], v9, s[28:31], s60 offen offset:0 sc1
    v_mfma_f32_16x16x32_bf16 v[200:203], a[252:255], a[188:191], v[200:203]
    v_cvt_pk_bf16_f32 v42, v240, v241
    v_cvt_pk_bf16_f32 v43, v242, v243
    v_mfma_f32_16x16x32_bf16 v[204:207], a[252:255], a[192:195], v[204:207]
    v_cvt_pk_bf16_f32 v46, v244, v245
    v_cvt_pk_bf16_f32 v47, v246, v247
    v_mfma_f32_16x16x32_bf16 v[208:211], a[252:255], a[196:199], v[208:211]
    s_waitcnt lgkmcnt(4)
    v_cvt_pk_bf16_f32 v50, v248, v249
    v_cvt_pk_bf16_f32 v51, v250, v251
    v_mfma_f32_16x16x32_bf16 v[172:175], a[240:243], a[200:203], v[172:175]
    ds_read_b64_tr_b16 a[252:253], v5 offset:45056
    ds_read_b64_tr_b16 a[254:255], v5 offset:47104
    v_mfma_f32_16x16x32_bf16 v[176:179], a[240:243], a[204:207], v[176:179]
    buffer_load_dwordx4 v8, s[24:27], s43 offen offset:3072 lds
    v_mfma_f32_16x16x32_bf16 v[180:183], a[240:243], a[208:211], v[180:183]
    s_add_u32 m0, s56, 4096
    s_add_u32 s42, s57, 32768
    v_mfma_f32_16x16x32_bf16 v[184:187], a[240:243], a[212:215], v[184:187]
    buffer_store_dwordx4 v[36:39], v9, s[28:31], s60 offen offset:1024 sc1
    v_mfma_f32_16x16x32_bf16 v[188:191], a[240:243], a[216:219], v[188:191]
    s_waitcnt lgkmcnt(4)
    v_mfma_f32_16x16x32_bf16 v[192:195], a[244:247], a[200:203], v[192:195]
    ds_read_b64_tr_b16 a[240:241], v6 offset:32768
    ds_read_b64_tr_b16 a[242:243], v6 offset:34816
    v_mfma_f32_16x16x32_bf16 v[196:199], a[244:247], a[204:207], v[196:199]
    v_mfma_f32_16x16x32_bf16 v[200:203], a[244:247], a[208:211], v[200:203]
    v_mfma_f32_16x16x32_bf16 v[204:207], a[244:247], a[212:215], v[204:207]
    s_add_u32 s43, s57, 39936
    buffer_load_dwordx4 v8, s[24:27], s42 offen offset:0 lds
    v_mfma_f32_16x16x32_bf16 v[208:211], a[244:247], a[216:219], v[208:211]
    s_waitcnt lgkmcnt(4)
    v_mfma_f32_16x16x32_bf16 v[172:175], a[248:251], a[220:223], v[172:175]
    ds_read_b64_tr_b16 a[244:245], v7 offset:32768
    ds_read_b64_tr_b16 a[246:247], v7 offset:34816
    v_mfma_f32_16x16x32_bf16 v[176:179], a[248:251], a[224:227], v[176:179]
    buffer_store_dwordx4 v[40:43], v9, s[28:31], s60 offen offset:2048 sc1
    v_mfma_f32_16x16x32_bf16 v[180:183], a[248:251], a[228:231], v[180:183]
    v_mfma_f32_16x16x32_bf16 v[184:187], a[248:251], a[232:235], v[184:187]
    v_mfma_f32_16x16x32_bf16 v[188:191], a[248:251], a[236:239], v[188:191]
    s_waitcnt lgkmcnt(4)
    v_mfma_f32_16x16x32_bf16 v[192:195], a[252:255], a[220:223], v[192:195]
    ds_read_b64_tr_b16 a[248:249], v6 offset:36864
    ds_read_b64_tr_b16 a[250:251], v6 offset:38912
    v_mfma_f32_16x16x32_bf16 v[196:199], a[252:255], a[224:227], v[196:199]
    s_add_u32 s42, s57, 47104
    buffer_load_dwordx4 v8, s[24:27], s43 offen offset:1024 lds
    v_mfma_f32_16x16x32_bf16 v[200:203], a[252:255], a[228:231], v[200:203]
    v_mfma_f32_16x16x32_bf16 v[204:207], a[252:255], a[232:235], v[204:207]
    buffer_store_dwordx4 v[44:47], v9, s[28:31], s60 offen offset:3072 sc1
    v_mfma_f32_16x16x32_bf16 v[208:211], a[252:255], a[236:239], v[208:211]
    s_waitcnt lgkmcnt(4)
    v_mfma_f32_16x16x32_bf16 v[172:175], a[240:243], a[0:3], v[172:175]
    ds_read_b64_tr_b16 a[252:253], v7 offset:36864
    ds_read_b64_tr_b16 a[254:255], v7 offset:38912
    v_mfma_f32_16x16x32_bf16 v[176:179], a[240:243], a[4:7], v[176:179]
    v_mfma_f32_16x16x32_bf16 v[180:183], a[240:243], a[8:11], v[180:183]
    s_add_u32 s43, s57, 54272
    buffer_load_dwordx4 v8, s[24:27], s42 offen offset:2048 lds
    v_mfma_f32_16x16x32_bf16 v[184:187], a[240:243], a[12:15], v[184:187]
    v_mfma_f32_16x16x32_bf16 v[188:191], a[240:243], a[16:19], v[188:191]
    s_waitcnt lgkmcnt(4)
    v_mfma_f32_16x16x32_bf16 v[192:195], a[244:247], a[0:3], v[192:195]
    ds_read_b64_tr_b16 a[240:241], v6 offset:40960
    ds_read_b64_tr_b16 a[242:243], v6 offset:43008
    v_mfma_f32_16x16x32_bf16 v[196:199], a[244:247], a[4:7], v[196:199]
    buffer_store_dwordx4 v[48:51], v9, s[28:31], s37 offen offset:0 sc1
    v_mfma_f32_16x16x32_bf16 v[200:203], a[244:247], a[8:11], v[200:203]
    v_mfma_f32_16x16x32_bf16 v[204:207], a[244:247], a[12:15], v[204:207]
    v_mfma_f32_16x16x32_bf16 v[208:211], a[244:247], a[16:19], v[208:211]
    s_waitcnt lgkmcnt(4)
    buffer_load_dwordx4 v8, s[24:27], s43 offen offset:3072 lds
    v_mfma_f32_16x16x32_bf16 v[172:175], a[248:251], a[20:23], v[172:175]
    ds_read_b64_tr_b16 a[244:245], v7 offset:40960
    ds_read_b64_tr_b16 a[246:247], v7 offset:43008
    v_mfma_f32_16x16x32_bf16 v[176:179], a[248:251], a[24:27], v[176:179]
    v_mfma_f32_16x16x32_bf16 v[180:183], a[248:251], a[28:31], v[180:183]
    v_mfma_f32_16x16x32_bf16 v[184:187], a[248:251], a[32:35], v[184:187]
    buffer_load_dword v51, off, s[16:19], s41 sc1
    v_mfma_f32_16x16x32_bf16 v[188:191], a[248:251], a[36:39], v[188:191]
    s_waitcnt lgkmcnt(4)
    s_lshl_b32 s38, s64, 7
    v_mfma_f32_16x16x32_bf16 v[192:195], a[252:255], a[20:23], v[192:195]
    s_add_u32 s38, s38, s54
    ds_read_b64_tr_b16 a[248:249], v6 offset:45056
    ds_read_b64_tr_b16 a[250:251], v6 offset:47104
    v_mfma_f32_16x16x32_bf16 v[196:199], a[252:255], a[24:27], v[196:199]
    s_add_u32 s64, s64, 1
    v_mfma_f32_16x16x32_bf16 v[200:203], a[252:255], a[28:31], v[200:203]
    s_and_b32 s64, s64, 7
    v_mfma_f32_16x16x32_bf16 v[204:207], a[252:255], a[32:35], v[204:207]
    s_mul_i32 s60, s64, 163840
    v_mfma_f32_16x16x32_bf16 v[208:211], a[252:255], a[36:39], v[208:211]
    s_waitcnt lgkmcnt(4)
    s_add_u32 s60, s60, s51
    v_mfma_f32_16x16x32_bf16 v[172:175], a[240:243], a[40:43], v[172:175]
    s_add_u32 s60, s60, s52
    ds_read_b64_tr_b16 a[252:253], v7 offset:45056
    ds_read_b64_tr_b16 a[254:255], v7 offset:47104
    v_mfma_f32_16x16x32_bf16 v[176:179], a[240:243], a[44:47], v[176:179]
    s_add_u32 s37, s60, 4096
    v_mfma_f32_16x16x32_bf16 v[180:183], a[240:243], a[48:51], v[180:183]
    s_cmp_eq_u32 s36, 2
    s_cselect_b32 s55, 0, s26
    v_mfma_f32_16x16x32_bf16 v[184:187], a[240:243], a[52:55], v[184:187]
    v_mfma_f32_16x16x32_bf16 v[188:191], a[240:243], a[56:59], v[188:191]
    s_waitcnt lgkmcnt(4)
    v_mfma_f32_16x16x32_bf16 v[192:195], a[244:247], a[40:43], v[192:195]
    v_mfma_f32_16x16x32_bf16 v[196:199], a[244:247], a[44:47], v[196:199]
    v_mfma_f32_16x16x32_bf16 v[200:203], a[244:247], a[48:51], v[200:203]
    v_mfma_f32_16x16x32_bf16 v[204:207], a[244:247], a[52:55], v[204:207]
    v_mfma_f32_16x16x32_bf16 v[208:211], a[244:247], a[56:59], v[208:211]
    s_waitcnt lgkmcnt(2)
    v_mfma_f32_16x16x32_bf16 v[172:175], a[248:251], a[60:63], v[172:175]
    s_waitcnt vmcnt(20) lgkmcnt(0)
    s_barrier
    v_mfma_f32_16x16x32_bf16 v[176:179], a[248:251], a[64:67], v[176:179]
    ds_read_b64_tr_b16 a[240:241], v4 offset:0
    ds_read_b64_tr_b16 a[242:243], v4 offset:2048
    v_mfma_f32_16x16x32_bf16 v[180:183], a[248:251], a[68:71], v[180:183]
    ds_read_b64_tr_b16 a[244:245], v5 offset:0
    ds_read_b64_tr_b16 a[246:247], v5 offset:2048
    v_mfma_f32_16x16x32_bf16 v[184:187], a[248:251], a[72:75], v[184:187]
    v_mfma_f32_16x16x32_bf16 v[188:191], a[248:251], a[76:79], v[188:191]
    v_mfma_f32_16x16x32_bf16 v[192:195], a[252:255], a[60:63], v[192:195]
    ds_read_b64_tr_b16 a[248:249], v4 offset:4096
    ds_read_b64_tr_b16 a[250:251], v4 offset:6144
    v_mfma_f32_16x16x32_bf16 v[196:199], a[252:255], a[64:67], v[196:199]
    v_mfma_f32_16x16x32_bf16 v[200:203], a[252:255], a[68:71], v[200:203]
    v_mfma_f32_16x16x32_bf16 v[204:207], a[252:255], a[72:75], v[204:207]
    v_mfma_f32_16x16x32_bf16 v[208:211], a[252:255], a[76:79], v[208:211]
    s_waitcnt lgkmcnt(4)
    s_add_u32 m0, s56, 32768
    s_add_u32 s42, s58, 0
    s_add_u32 s36, s36, 1
    s_branch L_oloop
L_otail:
    v_lshrrev_b32 v36, 4, v9
    v_and_b32 v37, 15, v36
    v_lshrrev_b32 v36, 4, v36
    v_lshlrev_b32 v37, 11, v37
    v_lshl_add_u32 v37, v36, 4, v37
    s_and_b32 s44, s96, 15
    s_mul_i32 s45, s44, 160
    s_mul_i32 s46, s34, 80
    s_add_u32 s45, s45, s46
    s_lshl_b32 s45, s45, 11
    s_lshr_b32 s46, s96, 4
    s_lshl_b32 s46, s46, 10
    s_add_u32 s45, s45, s46
    s_lshl_b32 s44, s44, 0
    s_add_u32 s44, s44, s97
    s_and_b32 s44, s44, 7
    s_lshl_b32 s44, s44, 7
    s_add_u32 s45, s45, s44
    s_lshl_b32 s46, s33, 6
    s_add_u32 s45, s45, s46
    s_waitcnt vmcnt(1)
    v_mfma_f32_16x16x32_bf16 v[52:55], v[12:15], v[20:23], v[52:55]
    v_mfma_f32_16x16x32_bf16 v[72:75], v[16:19], v[20:23], v[72:75]
    v_mfma_f32_16x16x32_bf16 v[56:59], v[12:15], v[24:27], v[56:59]
    v_mfma_f32_16x16x32_bf16 v[76:79], v[16:19], v[24:27], v[76:79]
    v_mfma_f32_16x16x32_bf16 v[60:63], v[12:15], v[28:31], v[60:63]
    v_mfma_f32_16x16x32_bf16 v[80:83], v[16:19], v[28:31], v[80:83]
    v_mfma_f32_16x16x32_bf16 v[64:67], v[12:15], v[252:255], v[64:67]
    v_mfma_f32_16x16x32_bf16 v[84:87], v[16:19], v[252:255], v[84:87]
    v_mfma_f32_16x16x32_bf16 v[68:71], v[12:15], v[0:3], v[68:71]
    v_mfma_f32_16x16x32_bf16 v[88:91], v[16:19], v[0:3], v[88:91]
    buffer_load_dword v51, off, s[16:19], s41 sc1
    v_add_f32 v212, v212, v52
    v_add_f32 v213, v213, v53
    v_add_f32 v214, v214, v54
    v_add_f32 v215, v215, v55
    v_add_f32 v216, v216, v56
    v_add_f32 v217, v217, v57
    v_add_f32 v218, v218, v58
    v_add_f32 v219, v219, v59
    v_add_f32 v220, v220, v60
    v_add_f32 v221, v221, v61
    v_add_f32 v222, v222, v62
    v_add_f32 v223, v223, v63
    v_add_f32 v224, v224, v64
    v_add_f32 v225, v225, v65
    v_add_f32 v226, v226, v66
    v_add_f32 v227, v227, v67
    v_add_f32 v228, v228, v68
    v_add_f32 v229, v229, v69
    v_add_f32 v230, v230, v70
    v_add_f32 v231, v231, v71
    v_add_f32 v232, v232, v72
    v_add_f32 v233, v233, v73
    v_add_f32 v234, v234, v74
    v_add_f32 v235, v235, v75
    v_add_f32 v236, v236, v76
    v_add_f32 v237, v237, v77
    v_add_f32 v238, v238, v78
    v_add_f32 v239, v239, v79
    v_add_f32 v240, v240, v80
    v_add_f32 v241, v241, v81
    v_add_f32 v242, v242, v82
    v_add_f32 v243, v243, v83
    v_add_f32 v244, v244, v84
    v_add_f32 v245, v245, v85
    v_add_f32 v246, v246, v86
    v_add_f32 v247, v247, v87
    v_add_f32 v248, v248, v88
    v_add_f32 v249, v249, v89
    v_add_f32 v250, v250, v90
    v_add_f32 v251, v251, v91
    s_waitcnt vmcnt(0)
    v_readfirstlane_b32 s3, v51
    s_nop 1
    s_or_b32 s3, s3, s62
    s_and_b32 s3, s3, s50
    s_cmp_eq_u32 s3, s50
    s_cbranch_scc0 L_spinOT
L_goOT:
    buffer_load_dwordx4 v[20:23], v9, s[20:23], s39 offen offset:0 sc1
    buffer_load_dwordx4 v[24:27], v9, s[20:23], s39 offen offset:1024 sc1
    buffer_load_dwordx4 v[28:31], v9, s[20:23], s39 offen offset:2048 sc1
    buffer_load_dwordx4 v[252:255], v9, s[20:23], s39 offen offset:3072 sc1
    buffer_load_dwordx4 v[0:3], v9, s[20:23], s40 offen offset:0 sc1
    s_waitcnt vmcnt(4)
    v_mfma_f32_16x16x32_bf16 v[212:215], v[12:15], v[20:23], v[212:215]
    v_mfma_f32_16x16x32_bf16 v[232:235], v[16:19], v[20:23], v[232:235]
    s_waitcnt vmcnt(3)
    v_mfma_f32_16x16x32_bf16 v[216:219], v[12:15], v[24:27], v[216:219]
    v_mfma_f32_16x16x32_bf16 v[236:239], v[16:19], v[24:27], v[236:239]
    s_waitcnt vmcnt(2)
    v_mfma_f32_16x16x32_bf16 v[220:223], v[12:15], v[28:31], v[220:223]
    v_mfma_f32_16x16x32_bf16 v[240:243], v[16:19], v[28:31], v[240:243]
    s_waitcnt vmcnt(1)
    v_mfma_f32_16x16x32_bf16 v[224:227], v[12:15], v[252:255], v[224:227]
    v_mfma_f32_16x16x32_bf16 v[244:247], v[16:19], v[252:255], v[244:247]
    s_waitcnt vmcnt(0)
    v_mfma_f32_16x16x32_bf16 v[228:231], v[12:15], v[0:3], v[228:231]
    v_mfma_f32_16x16x32_bf16 v[248:251], v[16:19], v[0:3], v[248:251]
    v_cvt_pk_bf16_f32 v92, v212, v213
    v_cvt_pk_bf16_f32 v93, v214, v215
    v_cvt_pk_bf16_f32 v94, v232, v233
    v_cvt_pk_bf16_f32 v95, v234, v235
    v_cvt_pk_bf16_f32 v96, v216, v217
    v_cvt_pk_bf16_f32 v97, v218, v219
    v_cvt_pk_bf16_f32 v98, v236, v237
    v_cvt_pk_bf16_f32 v99, v238, v239
    v_cvt_pk_bf16_f32 v100, v220, v221
    v_cvt_pk_bf16_f32 v101, v222, v223
    v_cvt_pk_bf16_f32 v102, v240, v241
    v_cvt_pk_bf16_f32 v103, v242, v243
    v_cvt_pk_bf16_f32 v104, v224, v225
    v_cvt_pk_bf16_f32 v105, v226, v227
    v_cvt_pk_bf16_f32 v106, v244, v245
    v_cvt_pk_bf16_f32 v107, v246, v247
    v_cvt_pk_bf16_f32 v108, v228, v229
    v_cvt_pk_bf16_f32 v109, v230, v231
    v_cvt_pk_bf16_f32 v110, v248, v249
    v_cvt_pk_bf16_f32 v111, v250, v251
    v_permlane32_swap_b32 v92, v94
    v_permlane32_swap_b32 v93, v95
    v_permlane32_swap_b32 v96, v98
    v_permlane32_swap_b32 v97, v99
    v_permlane32_swap_b32 v100, v102
    v_permlane32_swap_b32 v101, v103
    v_permlane32_swap_b32 v104, v106
    v_permlane32_swap_b32 v105, v107
    v_permlane32_swap_b32 v108, v110
    v_permlane32_swap_b32 v109, v111
    v_permlane16_swap_b32 v92, v94
    v_permlane16_swap_b32 v93, v95
    v_permlane16_swap_b32 v96, v98
    v_permlane16_swap_b32 v97, v99
    v_permlane16_swap_b32 v100, v102
    v_permlane16_swap_b32 v101, v103
    v_permlane16_swap_b32 v104, v106
    v_permlane16_swap_b32 v105, v107
    v_permlane16_swap_b32 v108, v110
    v_permlane16_swap_b32 v109, v111
    buffer_store_dwordx4 v[92:95], v37, s[12:15], s45 offen offset:0
    s_add_u32 s45, s45, 32768
    buffer_store_dwordx4 v[96:99], v37, s[12:15], s45 offen offset:0
    s_add_u32 s45, s45, 32768
    buffer_store_dwordx4 v[100:103], v37, s[12:15], s45 offen offset:0
    s_add_u32 s45, s45, 32768
    buffer_store_dwordx4 v[104:107], v37, s[12:15], s45 offen offset:0
    s_add_u32 s45, s45, 32768
    buffer_store_dwordx4 v[108:111], v37, s[12:15], s45 offen offset:0
L_end:
    s_endpgm
L_spinO1:
    s_mov_b32 s61, 0
L_splO1:
    s_sleep 6
    buffer_load_dword v51, off, s[16:19], s41 sc1
    s_waitcnt vmcnt(0)
    v_readfirstlane_b32 s3, v51
    s_nop 1
    s_and_b32 s3, s3, s50
    s_cmp_eq_u32 s3, s50
    s_cbranch_scc1 L_goO1
    s_add_u32 s61, s61, 1
    s_cmp_lt_u32 s61, 0x100000
    s_cbranch_scc1 L_splO1
    s_branch L_goO1
L_spinO3:
    s_mov_b32 s61, 0
L_splO3:
    s_sleep 6
    buffer_load_dword v51, off, s[16:19], s41 sc1
    s_waitcnt vmcnt(0)
    v_readfirstlane_b32 s3, v51
    s_nop 1
    s_and_b32 s3, s3, s50
    s_cmp_eq_u32 s3, s50
    s_cbranch_scc1 L_goO3
    s_add_u32 s61, s61, 1
    s_cmp_lt_u32 s61, 0x100000
    s_cbranch_scc1 L_splO3
    s_branch L_goO3
L_spinOT:
    s_mov_b32 s61, 0
L_splOT:
    s_sleep 6
    buffer_load_dword v51, off, s[16:19], s41 sc1
    s_waitcnt vmcnt(0)
    v_readfirstlane_b32 s3, v51
    s_nop 1
    s_and_b32 s3, s3, s50
    s_cmp_eq_u32 s3, s50
    s_cbranch_scc1 L_goOT
    s_add_u32 s61, s61, 1
    s_cmp_lt_u32 s61, 0x100000
    s_cbranch_scc1 L_splOT
    s_branch L_goOT
L_spinR:
    s_mov_b32 s61, 0
L_splR:
    s_sleep 8
    buffer_load_dword v35, v34, s[8:11], 0 offen sc1
    s_waitcnt vmcnt(0)
    v_readfirstlane_b32 s3, v35
    s_nop 1
    s_or_b32 s3, s3, s63
    s_and_b32 s3, s3, 0xff
    s_cmp_eq_u32 s3, 0xff
    s_cbranch_scc1 L_goR
    s_add_u32 s61, s61, 1
    s_cmp_lt_u32 s61, 0x100000
    s_cbranch_scc1 L_splR
    s_branch L_goR
L_fallback:
    s_waitcnt vmcnt(0) lgkmcnt(0)
    s_barrier
    s_mov_b32 s61, 1
    v_mov_b32 v212, 0xff800000
    v_mov_b32 v213, 0xff800000
    v_mov_b32 v214, 0xff800000
    v_mov_b32 v215, 0xff800000
    v_mov_b32 v216, 0xff800000
    s_lshl_b32 s37, s35, 17
    s_mov_b32 s36, 0
L_fb_loop:
    s_mov_b32 m0, s39
    s_nop 0
    buffer_load_dwordx4 v16, s[16:19], s37 offen offset:0 lds
    buffer_load_dwordx4 v17, s[16:19], s37 offen offset:1024 lds
    buffer_load_dwordx4 v18, s[16:19], s37 offen offset:2048 lds
    buffer_load_dwordx4 v19, s[16:19], s37 offen offset:3072 lds
    s_waitcnt vmcnt(0)
    s_barrier
    ds_read_b128 v[36:39], v4 offset:0
    ds_read_b128 v[40:43], v5 offset:0
    ds_read_b128 v[44:47], v6 offset:0
    ds_read_b128 v[48:51], v7 offset:0
    ds_read_b128 a[240:243], v4 offset:4096
    ds_read_b128 a[244:247], v5 offset:4096
    ds_read_b128 a[248:251], v6 offset:4096
    ds_read_b128 a[252:255], v7 offset:4096
    s_waitcnt lgkmcnt(0)
    s_barrier
    v_mfma_f32_16x16x32_bf16 v[172:175], v[36:39], v[92:95], 0
    v_mfma_f32_16x16x32_bf16 v[176:179], v[36:39], v[96:99], 0
    v_mfma_f32_16x16x32_bf16 v[180:183], v[36:39], v[100:103], 0
    v_mfma_f32_16x16x32_bf16 v[184:187], v[36:39], v[104:107], 0
    v_mfma_f32_16x16x32_bf16 v[188:191], v[36:39], v[108:111], 0
    v_mfma_f32_16x16x32_bf16 v[172:175], v[40:43], v[112:115], v[172:175]
    v_mfma_f32_16x16x32_bf16 v[176:179], v[40:43], v[116:119], v[176:179]
    v_mfma_f32_16x16x32_bf16 v[180:183], v[40:43], v[120:123], v[180:183]
    v_mfma_f32_16x16x32_bf16 v[184:187], v[40:43], v[124:127], v[184:187]
    v_mfma_f32_16x16x32_bf16 v[188:191], v[40:43], v[128:131], v[188:191]
    v_mfma_f32_16x16x32_bf16 v[172:175], v[44:47], v[132:135], v[172:175]
    v_mfma_f32_16x16x32_bf16 v[176:179], v[44:47], v[136:139], v[176:179]
    v_mfma_f32_16x16x32_bf16 v[180:183], v[44:47], v[140:143], v[180:183]
    v_mfma_f32_16x16x32_bf16 v[184:187], v[44:47], v[144:147], v[184:187]
    v_mfma_f32_16x16x32_bf16 v[188:191], v[44:47], v[148:151], v[188:191]
    v_mfma_f32_16x16x32_bf16 v[172:175], v[48:51], v[152:155], v[172:175]
    v_mfma_f32_16x16x32_bf16 v[176:179], v[48:51], v[156:159], v[176:179]
    v_mfma_f32_16x16x32_bf16 v[180:183], v[48:51], v[160:163], v[180:183]
    v_mfma_f32_16x16x32_bf16 v[184:187], v[48:51], v[164:167], v[184:187]
    v_mfma_f32_16x16x32_bf16 v[188:191], v[48:51], v[168:171], v[188:191]
    v_mfma_f32_16x16x32_bf16 v[192:195], a[240:243], v[92:95], 0
    v_mfma_f32_16x16x32_bf16 v[196:199], a[240:243], v[96:99], 0
    v_mfma_f32_16x16x32_bf16 v[200:203], a[240:243], v[100:103], 0
    v_mfma_f32_16x16x32_bf16 v[204:207], a[240:243], v[104:107], 0
    v_mfma_f32_16x16x32_bf16 v[208:211], a[240:243], v[108:111], 0
    v_mfma_f32_16x16x32_bf16 v[192:195], a[244:247], v[112:115], v[192:195]
    v_mfma_f32_16x16x32_bf16 v[196:199], a[244:247], v[116:119], v[196:199]
    v_mfma_f32_16x16x32_bf16 v[200:203], a[244:247], v[120:123], v[200:203]
    v_mfma_f32_16x16x32_bf16 v[204:207], a[244:247], v[124:127], v[204:207]
    v_mfma_f32_16x16x32_bf16 v[208:211], a[244:247], v[128:131], v[208:211]
    v_mfma_f32_16x16x32_bf16 v[192:195], a[248:251], v[132:135], v[192:195]
    v_mfma_f32_16x16x32_bf16 v[196:199], a[248:251], v[136:139], v[196:199]
    v_mfma_f32_16x16x32_bf16 v[200:203], a[248:251], v[140:143], v[200:203]
    v_mfma_f32_16x16x32_bf16 v[204:207], a[248:251], v[144:147], v[204:207]
    v_mfma_f32_16x16x32_bf16 v[208:211], a[248:251], v[148:151], v[208:211]
    v_mfma_f32_16x16x32_bf16 v[192:195], a[252:255], v[152:155], v[192:195]
    v_mfma_f32_16x16x32_bf16 v[196:199], a[252:255], v[156:159], v[196:199]
    v_mfma_f32_16x16x32_bf16 v[200:203], a[252:255], v[160:163], v[200:203]
    v_mfma_f32_16x16x32_bf16 v[204:207], a[252:255], v[164:167], v[204:207]
    v_mfma_f32_16x16x32_bf16 v[208:211], a[252:255], v[168:171], v[208:211]
    s_nop 9
    v_max3_f32 v212, v212, v172, v173
    v_max3_f32 v212, v212, v174, v175
    v_max3_f32 v212, v212, v192, v193
    v_max3_f32 v212, v212, v194, v195
    v_max3_f32 v213, v213, v176, v177
    v_max3_f32 v213, v213, v178, v179
    v_max3_f32 v213, v213, v196, v197
    v_max3_f32 v213, v213, v198, v199
    v_max3_f32 v214, v214, v180, v181
    v_max3_f32 v214, v214, v182, v183
    v_max3_f32 v214, v214, v200, v201
    v_max3_f32 v214, v214, v202, v203
    v_max3_f32 v215, v215, v184, v185
    v_max3_f32 v215, v215, v186, v187
    v_max3_f32 v215, v215, v204, v205
    v_max3_f32 v215, v215, v206, v207
    v_max3_f32 v216, v216, v188, v189
    v_max3_f32 v216, v216, v190, v191
    v_max3_f32 v216, v216, v208, v209
    v_max3_f32 v216, v216, v210, v211
    s_add_u32 s37, s37, 8192
    s_add_u32 s36, s36, 1
    s_cmp_lt_u32 s36, 16
    s_cbranch_scc1 L_fb_loop
    v_mov_b32 v1, v212
    s_nop 1
    v_permlane32_swap_b32 v212, v1
    s_nop 1
    v_max_f32 v212, v212, v1
    v_mov_b32 v1, v212
    s_nop 1
    v_permlane16_swap_b32 v212, v1
    s_nop 1
    v_max_f32 v212, v212, v1
    v_sub_f32 v72, 0, v212
    v_sub_f32 v73, 0, v212
    v_sub_f32 v74, 0, v212
    v_sub_f32 v75, 0, v212
    v_mov_b32 v1, v213
    s_nop 1
    v_permlane32_swap_b32 v213, v1
    s_nop 1
    v_max_f32 v213, v213, v1
    v_mov_b32 v1, v213
    s_nop 1
    v_permlane16_swap_b32 v213, v1
    s_nop 1
    v_max_f32 v213, v213, v1
    v_sub_f32 v76, 0, v213
    v_sub_f32 v77, 0, v213
    v_sub_f32 v78, 0, v213
    v_sub_f32 v79, 0, v213
    v_mov_b32 v1, v214
    s_nop 1
    v_permlane32_swap_b32 v214, v1
    s_nop 1
    v_max_f32 v214, v214, v1
    v_mov_b32 v1, v214
    s_nop 1
    v_permlane16_swap_b32 v214, v1
    s_nop 1
    v_max_f32 v214, v214, v1
    v_sub_f32 v80, 0, v214
    v_sub_f32 v81, 0, v214
    v_sub_f32 v82, 0, v214
    v_sub_f32 v83, 0, v214
    v_mov_b32 v1, v215
    s_nop 1
    v_permlane32_swap_b32 v215, v1
    s_nop 1
    v_max_f32 v215, v215, v1
    v_mov_b32 v1, v215
    s_nop 1
    v_permlane16_swap_b32 v215, v1
    s_nop 1
    v_max_f32 v215, v215, v1
    v_sub_f32 v84, 0, v215
    v_sub_f32 v85, 0, v215
    v_sub_f32 v86, 0, v215
    v_sub_f32 v87, 0, v215
    v_mov_b32 v1, v216
    s_nop 1
    v_permlane32_swap_b32 v216, v1
    s_nop 1
    v_max_f32 v216, v216, v1
    v_mov_b32 v1, v216
    s_nop 1
    v_permlane16_swap_b32 v216, v1
    s_nop 1
    v_max_f32 v216, v216, v1
    v_sub_f32 v88, 0, v216
    v_sub_f32 v89, 0, v216
    v_sub_f32 v90, 0, v216
    v_sub_f32 v91, 0, v216
    s_lshl_b32 s63, s35, 17
    s_add_u32 s42, s63, 0
    s_add_u32 m0, s39, 0
    s_nop 0
    buffer_load_dwordx4 v16, s[16:19], s42 offen offset:0 nt lds
    buffer_load_dwordx4 v17, s[16:19], s42 offen offset:1024 nt lds
    buffer_load_dwordx4 v18, s[16:19], s42 offen offset:2048 nt lds
    buffer_load_dwordx4 v19, s[16:19], s42 offen offset:3072 nt lds
    s_lshl_b32 s63, s35, 17
    s_add_u32 s42, s63, 0
    s_add_u32 m0, s39, 8192
    s_nop 0
    buffer_load_dwordx4 v16, s[20:23], s42 offen offset:0 nt lds
    buffer_load_dwordx4 v17, s[20:23], s42 offen offset:1024 nt lds
    buffer_load_dwordx4 v18, s[20:23], s42 offen offset:2048 nt lds
    buffer_load_dwordx4 v19, s[20:23], s42 offen offset:3072 nt lds
    s_lshl_b32 s63, s35, 17
    s_add_u32 s42, s63, 8192
    s_add_u32 m0, s39, 16384
    s_nop 0
    buffer_load_dwordx4 v16, s[16:19], s42 offen offset:0 nt lds
    buffer_load_dwordx4 v17, s[16:19], s42 offen offset:1024 nt lds
    buffer_load_dwordx4 v18, s[16:19], s42 offen offset:2048 nt lds
    buffer_load_dwordx4 v19, s[16:19], s42 offen offset:3072 nt lds
    s_lshl_b32 s63, s35, 17
    s_add_u32 s42, s63, 16384
    s_add_u32 m0, s39, 32768
    s_nop 0
    buffer_load_dwordx4 v16, s[16:19], s42 offen offset:0 nt lds
    buffer_load_dwordx4 v17, s[16:19], s42 offen offset:1024 nt lds
    buffer_load_dwordx4 v18, s[16:19], s42 offen offset:2048 nt lds
    buffer_load_dwordx4 v19, s[16:19], s42 offen offset:3072 nt lds
    s_lshl_b32 s63, s35, 17
    s_add_u32 s42, s63, 8192
    s_add_u32 m0, s39, 24576
    s_nop 0
    buffer_load_dwordx4 v16, s[20:23], s42 offen offset:0 nt lds
    buffer_load_dwordx4 v17, s[20:23], s42 offen offset:1024 nt lds
    buffer_load_dwordx4 v18, s[20:23], s42 offen offset:2048 nt lds
    buffer_load_dwordx4 v19, s[20:23], s42 offen offset:3072 nt lds
    s_lshl_b32 s63, s35, 17
    s_add_u32 s42, s63, 24576
    s_add_u32 m0, s39, 49152
    s_nop 0
    buffer_load_dwordx4 v16, s[16:19], s42 offen offset:0 nt lds
    buffer_load_dwordx4 v17, s[16:19], s42 offen offset:1024 nt lds
    buffer_load_dwordx4 v18, s[16:19], s42 offen offset:2048 nt lds
    buffer_load_dwordx4 v19, s[16:19], s42 offen offset:3072 nt lds
    s_waitcnt vmcnt(0)
    s_barrier
    s_branch L_attn
L_qepx:
L_e0x:
L_attn:
    s_lshl_b32 s63, s35, 17
    s_add_u32 s37, s63, 32768
    s_add_u32 s38, s63, 24576
    s_mov_b32 s36, 0
    ds_read_b128 v[36:39], v4 offset:0
    ds_read_b128 v[40:43], v5 offset:0
    ds_read_b128 v[44:47], v6 offset:0
    ds_read_b128 v[48:51], v7 offset:0
    ds_read_b128 a[240:243], v4 offset:4096
    ds_read_b128 a[244:247], v5 offset:4096
    ds_read_b128 a[248:251], v6 offset:4096
    ds_read_b128 a[252:255], v7 offset:4096
    s_waitcnt lgkmcnt(7)
    v_mfma_f32_16x16x32_bf16 v[172:175], v[36:39], v[92:95], v[72:75]
    v_mfma_f32_16x16x32_bf16 v[176:179], v[36:39], v[96:99], v[76:79]
    s_lshl_b32 s63, s35, 17
    s_add_u32 s42, s63, 16384
    s_add_u32 m0, s39, 40960
    v_mfma_f32_16x16x32_bf16 v[180:183], v[36:39], v[100:103], v[80:83]
    v_mfma_f32_16x16x32_bf16 v[184:187], v[36:39], v[104:107], v[84:87]
    buffer_load_dwordx4 v16, s[20:23], s42 offen offset:0 nt lds
    v_mfma_f32_16x16x32_bf16 v[188:191], v[36:39], v[108:111], v[88:91]
    s_waitcnt lgkmcnt(6)
    v_mfma_f32_16x16x32_bf16 v[172:175], v[40:43], v[112:115], v[172:175]
    v_mfma_f32_16x16x32_bf16 v[176:179], v[40:43], v[116:119], v[176:179]
    v_mfma_f32_16x16x32_bf16 v[180:183], v[40:43], v[120:123], v[180:183]
    v_mfma_f32_16x16x32_bf16 v[184:187], v[40:43], v[124:127], v[184:187]
    buffer_load_dwordx4 v17, s[20:23], s42 offen offset:1024 nt lds
    v_mfma_f32_16x16x32_bf16 v[188:191], v[40:43], v[128:131], v[188:191]
    s_waitcnt lgkmcnt(5)
    v_mfma_f32_16x16x32_bf16 v[172:175], v[44:47], v[132:135], v[172:175]
    v_mfma_f32_16x16x32_bf16 v[176:179], v[44:47], v[136:139], v[176:179]
    v_mfma_f32_16x16x32_bf16 v[180:183], v[44:47], v[140:143], v[180:183]
    v_mfma_f32_16x16x32_bf16 v[184:187], v[44:47], v[144:147], v[184:187]
    buffer_load_dwordx4 v18, s[20:23], s42 offen offset:2048 nt lds
    v_mfma_f32_16x16x32_bf16 v[188:191], v[44:47], v[148:151], v[188:191]
    s_waitcnt lgkmcnt(4)
    v_mfma_f32_16x16x32_bf16 v[172:175], v[48:51], v[152:155], v[172:175]
    v_mfma_f32_16x16x32_bf16 v[176:179], v[48:51], v[156:159], v[176:179]
    v_mfma_f32_16x16x32_bf16 v[180:183], v[48:51], v[160:163], v[180:183]
    v_mfma_f32_16x16x32_bf16 v[184:187], v[48:51], v[164:167], v[184:187]
    buffer_load_dwordx4 v19, s[20:23], s42 offen offset:3072 nt lds
    v_mfma_f32_16x16x32_bf16 v[188:191], v[48:51], v[168:171], v[188:191]
    s_waitcnt lgkmcnt(3)
    v_mfma_f32_16x16x32_bf16 v[192:195], a[240:243], v[92:95], v[72:75]
    v_mfma_f32_16x16x32_bf16 v[196:199], a[240:243], v[96:99], v[76:79]
    v_mfma_f32_16x16x32_bf16 v[200:203], a[240:243], v[100:103], v[80:83]
    v_exp_f32 v172, v172
    v_mfma_f32_16x16x32_bf16 v[204:207], a[240:243], v[104:107], v[84:87]
    v_mfma_f32_16x16x32_bf16 v[208:211], a[240:243], v[108:111], v[88:91]
    s_waitcnt lgkmcnt(2)
    v_mfma_f32_16x16x32_bf16 v[192:195], a[244:247], v[112:115], v[192:195]
    v_exp_f32 v173, v173
    v_mfma_f32_16x16x32_bf16 v[196:199], a[244:247], v[116:119], v[196:199]
    v_exp_f32 v174, v174
    v_mfma_f32_16x16x32_bf16 v[200:203], a[244:247], v[120:123], v[200:203]
    v_exp_f32 v175, v175
    v_mfma_f32_16x16x32_bf16 v[204:207], a[244:247], v[124:127], v[204:207]
    v_mfma_f32_16x16x32_bf16 v[208:211], a[244:247], v[128:131], v[208:211]
    s_waitcnt lgkmcnt(1)
    v_mfma_f32_16x16x32_bf16 v[192:195], a[248:251], v[132:135], v[192:195]
    v_cvt_pk_bf16_f32 v212, v172, v173
    v_cvt_pk_bf16_f32 v213, v174, v175
    v_mfma_f32_16x16x32_bf16 v[196:199], a[248:251], v[136:139], v[196:199]
    v_exp_f32 v176, v176
    v_mfma_f32_16x16x32_bf16 v[200:203], a[248:251], v[140:143], v[200:203]
    v_mfma_f32_16x16x32_bf16 v[204:207], a[248:251], v[144:147], v[204:207]
    v_exp_f32 v177, v177
    v_mfma_f32_16x16x32_bf16 v[208:211], a[248:251], v[148:151], v[208:211]
    s_waitcnt lgkmcnt(0)
    v_exp_f32 v178, v178
    v_mfma_f32_16x16x32_bf16 v[192:195], a[252:255], v[152:155], v[192:195]
    v_exp_f32 v179, v179
    v_mfma_f32_16x16x32_bf16 v[196:199], a[252:255], v[156:159], v[196:199]
    v_mfma_f32_16x16x32_bf16 v[200:203], a[252:255], v[160:163], v[200:203]
    v_cvt_pk_bf16_f32 v216, v176, v177
    v_cvt_pk_bf16_f32 v217, v178, v179
    v_mfma_f32_16x16x32_bf16 v[204:207], a[252:255], v[164:167], v[204:207]
    v_exp_f32 v180, v180
    v_mfma_f32_16x16x32_bf16 v[208:211], a[252:255], v[168:171], v[208:211]
    v_exp_f32 v181, v181
    v_exp_f32 v182, v182
    v_exp_f32 v183, v183
    v_cvt_pk_bf16_f32 v220, v180, v181
    v_cvt_pk_bf16_f32 v221, v182, v183
    v_exp_f32 v184, v184
    v_exp_f32 v185, v185
    v_exp_f32 v186, v186
    v_exp_f32 v187, v187
    v_cvt_pk_bf16_f32 v224, v184, v185
    v_cvt_pk_bf16_f32 v225, v186, v187
    v_exp_f32 v188, v188
    v_exp_f32 v189, v189
    v_exp_f32 v190, v190
    v_exp_f32 v191, v191
    v_cvt_pk_bf16_f32 v228, v188, v189
    v_cvt_pk_bf16_f32 v229, v190, v191
    v_exp_f32 v192, v192
    v_exp_f32 v193, v193
    v_exp_f32 v194, v194
    v_exp_f32 v195, v195
    v_cvt_pk_bf16_f32 v214, v192, v193
    v_cvt_pk_bf16_f32 v215, v194, v195
    v_exp_f32 v196, v196
    v_exp_f32 v197, v197
    v_exp_f32 v198, v198
    v_exp_f32 v199, v199
    v_cvt_pk_bf16_f32 v218, v196, v197
    v_cvt_pk_bf16_f32 v219, v198, v199
    v_exp_f32 v200, v200
    v_exp_f32 v201, v201
    v_exp_f32 v202, v202
    v_exp_f32 v203, v203
    s_waitcnt lgkmcnt(0)
    s_barrier
    s_add_u32 m0, s39, 0
    ds_read_b128 v[36:39], v4 offset:16384
    ds_read_b128 v[40:43], v5 offset:16384
    buffer_load_dwordx4 v16, s[16:19], s37 offen offset:0 nt lds
    v_cvt_pk_bf16_f32 v222, v200, v201
    v_cvt_pk_bf16_f32 v223, v202, v203
    v_exp_f32 v204, v204
    ds_read_b128 v[44:47], v6 offset:16384
    v_exp_f32 v205, v205
    v_exp_f32 v206, v206
    buffer_load_dwordx4 v17, s[16:19], s37 offen offset:1024 nt lds
    v_exp_f32 v207, v207
    ds_read_b128 v[48:51], v7 offset:16384
    v_cvt_pk_bf16_f32 v226, v204, v205
    v_cvt_pk_bf16_f32 v227, v206, v207
    v_exp_f32 v208, v208
    v_exp_f32 v209, v209
    s_waitcnt lgkmcnt(3)
    buffer_load_dwordx4 v18, s[16:19], s37 offen offset:2048 nt lds
    v_mfma_f32_16x16x32_bf16 v[172:175], v[36:39], v[92:95], v[72:75]
    ds_read_b128 a[240:243], v4 offset:20480
    v_cvt_pk_bf16_f32 v230, v208, v209
    v_mfma_f32_16x16x32_bf16 v[176:179], v[36:39], v[96:99], v[76:79]
    v_exp_f32 v210, v210
    v_mfma_f32_16x16x32_bf16 v[180:183], v[36:39], v[100:103], v[80:83]
    v_exp_f32 v211, v211
    v_mfma_f32_16x16x32_bf16 v[184:187], v[36:39], v[104:107], v[84:87]
    v_cvt_pk_bf16_f32 v231, v210, v211
    v_mfma_f32_16x16x32_bf16 v[188:191], v[36:39], v[108:111], v[88:91]
    s_waitcnt lgkmcnt(3)
    v_mfma_f32_16x16x32_bf16 v[172:175], v[40:43], v[112:115], v[172:175]
    buffer_load_dwordx4 v19, s[16:19], s37 offen offset:3072 nt lds
    v_mfma_f32_16x16x32_bf16 v[176:179], v[40:43], v[116:119], v[176:179]
    s_add_u32 m0, s39, 57344
    s_add_u32 s37, s37, 8192
    ds_read_b128 a[244:247], v5 offset:20480
    v_mfma_f32_16x16x32_bf16 v[180:183], v[40:43], v[120:123], v[180:183]
    v_mfma_f32_16x16x32_bf16 v[184:187], v[40:43], v[124:127], v[184:187]
    v_mfma_f32_16x16x32_bf16 v[188:191], v[40:43], v[128:131], v[188:191]
    s_waitcnt lgkmcnt(3)
    v_mfma_f32_16x16x32_bf16 v[172:175], v[44:47], v[132:135], v[172:175]
    ds_read_b128 a[248:251], v6 offset:20480
    v_mfma_f32_16x16x32_bf16 v[176:179], v[44:47], v[136:139], v[176:179]
    buffer_load_dwordx4 v16, s[20:23], s38 offen offset:0 nt lds
    v_mfma_f32_16x16x32_bf16 v[180:183], v[44:47], v[140:143], v[180:183]
    v_mfma_f32_16x16x32_bf16 v[184:187], v[44:47], v[144:147], v[184:187]
    v_mfma_f32_16x16x32_bf16 v[188:191], v[44:47], v[148:151], v[188:191]
    s_waitcnt lgkmcnt(3)
    v_mfma_f32_16x16x32_bf16 v[172:175], v[48:51], v[152:155], v[172:175]
    ds_read_b128 a[252:255], v7 offset:20480
    v_mfma_f32_16x16x32_bf16 v[176:179], v[48:51], v[156:159], v[176:179]
    v_mfma_f32_16x16x32_bf16 v[180:183], v[48:51], v[160:163], v[180:183]
    buffer_load_dwordx4 v17, s[20:23], s38 offen offset:1024 nt lds
    v_mfma_f32_16x16x32_bf16 v[184:187], v[48:51], v[164:167], v[184:187]
    v_mfma_f32_16x16x32_bf16 v[188:191], v[48:51], v[168:171], v[188:191]
    s_waitcnt lgkmcnt(3)
    v_mfma_f32_16x16x32_bf16 v[192:195], a[240:243], v[92:95], v[72:75]
    ds_read_b64_tr_b16 v[36:37], v8 offset:0
    ds_read_b64_tr_b16 v[38:39], v8 offset:4096
    v_mfma_f32_16x16x32_bf16 v[196:199], a[240:243], v[96:99], v[76:79]
    v_mfma_f32_16x16x32_bf16 v[200:203], a[240:243], v[100:103], v[80:83]
    v_exp_f32 v172, v172
    v_mfma_f32_16x16x32_bf16 v[204:207], a[240:243], v[104:107], v[84:87]
    buffer_load_dwordx4 v18, s[20:23], s38 offen offset:2048 nt lds
    v_mfma_f32_16x16x32_bf16 v[208:211], a[240:243], v[108:111], v[88:91]
    s_waitcnt lgkmcnt(4)
    ds_read_b64_tr_b16 v[40:41], v9 offset:0
    ds_read_b64_tr_b16 v[42:43], v9 offset:4096
    v_mfma_f32_16x16x32_bf16 v[192:195], a[244:247], v[112:115], v[192:195]
    v_exp_f32 v173, v173
    v_mfma_f32_16x16x32_bf16 v[196:199], a[244:247], v[116:119], v[196:199]
    v_exp_f32 v174, v174
    v_mfma_f32_16x16x32_bf16 v[200:203], a[244:247], v[120:123], v[200:203]
    v_exp_f32 v175, v175
    v_mfma_f32_16x16x32_bf16 v[204:207], a[244:247], v[124:127], v[204:207]
    ds_read_b64_tr_b16 v[44:45], v10 offset:0
    ds_read_b64_tr_b16 v[46:47], v10 offset:4096
    v_mfma_f32_16x16x32_bf16 v[208:211], a[244:247], v[128:131], v[208:211]
    s_waitcnt lgkmcnt(7)
    buffer_load_dwordx4 v19, s[20:23], s38 offen offset:3072 nt lds
    v_mfma_f32_16x16x32_bf16 v[192:195], a[248:251], v[132:135], v[192:195]
    s_add_u32 s38, s38, 8192
    v_cvt_pk_bf16_f32 v232, v172, v173
    v_cvt_pk_bf16_f32 v233, v174, v175
    v_mfma_f32_16x16x32_bf16 v[196:199], a[248:251], v[136:139], v[196:199]
    v_exp_f32 v176, v176
    v_mfma_f32_16x16x32_bf16 v[200:203], a[248:251], v[140:143], v[200:203]
    ds_read_b64_tr_b16 v[48:49], v11 offset:0
    ds_read_b64_tr_b16 v[50:51], v11 offset:4096
    v_mfma_f32_16x16x32_bf16 v[204:207], a[248:251], v[144:147], v[204:207]
    v_exp_f32 v177, v177
    v_mfma_f32_16x16x32_bf16 v[208:211], a[248:251], v[148:151], v[208:211]
    s_waitcnt lgkmcnt(8)
    v_exp_f32 v178, v178
    v_mfma_f32_16x16x32_bf16 v[192:195], a[252:255], v[152:155], v[192:195]
    v_exp_f32 v179, v179
    v_mfma_f32_16x16x32_bf16 v[196:199], a[252:255], v[156:159], v[196:199]
    ds_read_b64_tr_b16 a[240:241], v12 offset:0
    ds_read_b64_tr_b16 a[242:243], v12 offset:4096
    v_mfma_f32_16x16x32_bf16 v[200:203], a[252:255], v[160:163], v[200:203]
    v_cvt_pk_bf16_f32 v236, v176, v177
    v_cvt_pk_bf16_f32 v237, v178, v179
    v_mfma_f32_16x16x32_bf16 v[204:207], a[252:255], v[164:167], v[204:207]
    v_exp_f32 v180, v180
    v_mfma_f32_16x16x32_bf16 v[208:211], a[252:255], v[168:171], v[208:211]
    v_exp_f32 v181, v181
    v_mfma_f32_16x16x32_bf16 v[52:55], v[32:35], v[212:215], 0
    ds_read_b64_tr_b16 a[244:245], v13 offset:0
    ds_read_b64_tr_b16 a[246:247], v13 offset:4096
    v_mfma_f32_16x16x32_bf16 v[56:59], v[32:35], v[216:219], 0
    v_exp_f32 v182, v182
    v_mfma_f32_16x16x32_bf16 v[60:63], v[32:35], v[220:223], 0
    v_exp_f32 v183, v183
    v_mfma_f32_16x16x32_bf16 v[64:67], v[32:35], v[224:227], 0
    v_cvt_pk_bf16_f32 v240, v180, v181
    v_cvt_pk_bf16_f32 v241, v182, v183
    v_mfma_f32_16x16x32_bf16 v[68:71], v[32:35], v[228:231], 0
    s_waitcnt lgkmcnt(10)
    ds_read_b64_tr_b16 a[248:249], v14 offset:0
    ds_read_b64_tr_b16 a[250:251], v14 offset:4096
    v_mfma_f32_16x16x32_bf16 a[0:3], v[36:39], v[212:215], 0
    v_exp_f32 v184, v184
    v_mfma_f32_16x16x32_bf16 a[4:7], v[36:39], v[216:219], 0
    v_exp_f32 v185, v185
    v_mfma_f32_16x16x32_bf16 a[8:11], v[36:39], v[220:223], 0
    v_exp_f32 v186, v186
    v_mfma_f32_16x16x32_bf16 a[12:15], v[36:39], v[224:227], 0
    ds_read_b64_tr_b16 a[252:253], v15 offset:0
    ds_read_b64_tr_b16 a[254:255], v15 offset:4096
    v_mfma_f32_16x16x32_bf16 a[16:19], v[36:39], v[228:231], 0
    s_waitcnt lgkmcnt(12)
    v_exp_f32 v187, v187
    v_mfma_f32_16x16x32_bf16 a[20:23], v[40:43], v[212:215], 0
    v_cvt_pk_bf16_f32 v244, v184, v185
    v_cvt_pk_bf16_f32 v245, v186, v187
    v_mfma_f32_16x16x32_bf16 a[24:27], v[40:43], v[216:219], 0
    v_exp_f32 v188, v188
    v_mfma_f32_16x16x32_bf16 a[28:31], v[40:43], v[220:223], 0
    v_exp_f32 v189, v189
    v_mfma_f32_16x16x32_bf16 a[32:35], v[40:43], v[224:227], 0
    v_exp_f32 v190, v190
    v_mfma_f32_16x16x32_bf16 a[36:39], v[40:43], v[228:231], 0
    s_waitcnt lgkmcnt(10)
    v_exp_f32 v191, v191
    v_mfma_f32_16x16x32_bf16 a[40:43], v[44:47], v[212:215], 0
    v_cvt_pk_bf16_f32 v248, v188, v189
    v_cvt_pk_bf16_f32 v249, v190, v191
    v_mfma_f32_16x16x32_bf16 a[44:47], v[44:47], v[216:219], 0
    v_exp_f32 v192, v192
    v_mfma_f32_16x16x32_bf16 a[48:51], v[44:47], v[220:223], 0
    v_exp_f32 v193, v193
    v_mfma_f32_16x16x32_bf16 a[52:55], v[44:47], v[224:227], 0
    v_exp_f32 v194, v194
    v_mfma_f32_16x16x32_bf16 a[56:59], v[44:47], v[228:231], 0
    s_waitcnt lgkmcnt(8)
    v_exp_f32 v195, v195
    v_mfma_f32_16x16x32_bf16 a[60:63], v[48:51], v[212:215], 0
    v_cvt_pk_bf16_f32 v234, v192, v193
    v_cvt_pk_bf16_f32 v235, v194, v195
    v_mfma_f32_16x16x32_bf16 a[64:67], v[48:51], v[216:219], 0
    v_exp_f32 v196, v196
    v_mfma_f32_16x16x32_bf16 a[68:71], v[48:51], v[220:223], 0
    v_exp_f32 v197, v197
    v_mfma_f32_16x16x32_bf16 a[72:75], v[48:51], v[224:227], 0
    v_exp_f32 v198, v198
    v_mfma_f32_16x16x32_bf16 a[76:79], v[48:51], v[228:231], 0
    s_waitcnt lgkmcnt(6)
    v_exp_f32 v199, v199
    v_mfma_f32_16x16x32_bf16 a[80:83], a[240:243], v[212:215], 0
    v_cvt_pk_bf16_f32 v238, v196, v197
    v_cvt_pk_bf16_f32 v239, v198, v199
    v_mfma_f32_16x16x32_bf16 a[84:87], a[240:243], v[216:219], 0
    v_exp_f32 v200, v200
    v_mfma_f32_16x16x32_bf16 a[88:91], a[240:243], v[220:223], 0
    v_exp_f32 v201, v201
    v_mfma_f32_16x16x32_bf16 a[92:95], a[240:243], v[224:227], 0
    v_exp_f32 v202, v202
    v_mfma_f32_16x16x32_bf16 a[96:99], a[240:243], v[228:231], 0
    s_waitcnt lgkmcnt(4)
    v_exp_f32 v203, v203
    v_mfma_f32_16x16x32_bf16 a[100:103], a[244:247], v[212:215], 0
    s_waitcnt lgkmcnt(0)
    s_barrier
    v_mfma_f32_16x16x32_bf16 a[104:107], a[244:247], v[216:219], 0
    s_add_u32 m0, s39, 16384
    ds_read_b128 v[36:39], v4 offset:32768
    ds_read_b128 v[40:43], v5 offset:32768
    v_mfma_f32_16x16x32_bf16 a[108:111], a[244:247], v[220:223], 0
    buffer_load_dwordx4 v16, s[16:19], s37 offen offset:0 nt lds
    v_mfma_f32_16x16x32_bf16 a[112:115], a[244:247], v[224:227], 0
    v_cvt_pk_bf16_f32 v242, v200, v201
    v_cvt_pk_bf16_f32 v243, v202, v203
    v_mfma_f32_16x16x32_bf16 a[116:119], a[244:247], v[228:231], 0
    v_exp_f32 v204, v204
    v_mfma_f32_16x16x32_bf16 a[120:123], a[248:251], v[212:215], 0
    ds_read_b128 v[44:47], v6 offset:32768
    v_mfma_f32_16x16x32_bf16 a[124:127], a[248:251], v[216:219], 0
    v_exp_f32 v205, v205
    v_mfma_f32_16x16x32_bf16 a[128:131], a[248:251], v[220:223], 0
    v_exp_f32 v206, v206
    v_mfma_f32_16x16x32_bf16 a[132:135], a[248:251], v[224:227], 0
    buffer_load_dwordx4 v17, s[16:19], s37 offen offset:1024 nt lds
    v_mfma_f32_16x16x32_bf16 a[136:139], a[248:251], v[228:231], 0
    v_exp_f32 v207, v207
    v_mfma_f32_16x16x32_bf16 a[140:143], a[252:255], v[212:215], 0
    ds_read_b128 v[48:51], v7 offset:32768
    v_cvt_pk_bf16_f32 v246, v204, v205
    v_mfma_f32_16x16x32_bf16 a[144:147], a[252:255], v[216:219], 0
    v_cvt_pk_bf16_f32 v247, v206, v207
    v_mfma_f32_16x16x32_bf16 a[148:151], a[252:255], v[220:223], 0
    v_exp_f32 v208, v208
    v_mfma_f32_16x16x32_bf16 a[152:155], a[252:255], v[224:227], 0
    v_exp_f32 v209, v209
    v_mfma_f32_16x16x32_bf16 a[156:159], a[252:255], v[228:231], 0
    s_waitcnt lgkmcnt(3)
    buffer_load_dwordx4 v18, s[16:19], s37 offen offset:2048 nt lds
    s_branch L_aloop
.section .rodata,"a"
.p2align 6
.amdhsa_kernel concat_heads__mha_block_cached__mha_block_cached__near_ridge_kernel
  .amdhsa_next_free_vgpr 512
  .amdhsa_next_free_sgpr 102
  .amdhsa_accum_offset 256
  .amdhsa_group_segment_fixed_size 0
  .amdhsa_kernarg_size 104
  .amdhsa_user_sgpr_count 2
  .amdhsa_user_sgpr_kernarg_segment_ptr 1
  .amdhsa_system_sgpr_workgroup_id_x 1
.end_amdhsa_kernel
```
